```python
import torch

def _softmax(x, axis=-1):
    return torch.softmax(x, dim=axis)
def _gelu(x):
    return torch.nn.functional.gelu(x, approximate="tanh")
def _silu(x):
    return torch.nn.functional.silu(x)
def _sigmoid(x):
    return torch.sigmoid(x)
def _layernorm(x, axis=-1, eps=1e-5):
    m = x.mean(dim=axis, keepdim=True)
    v = x.var(dim=axis, keepdim=True, unbiased=False)
    return (x - m) / torch.sqrt(v + eps)
def _scatter_add(tgt, idx, src, axis=0):
    return tgt.clone().index_add_(axis, idx, src)
def _segment_sum(src, seg, n):
    out = torch.zeros((n,) + src.shape[1:], dtype=src.dtype)
    return out.index_add_(0, seg, src)
def _pad(x, pw):
    flat = tuple(v for pair in reversed(pw) for v in pair)
    return torch.nn.functional.pad(x, flat)

kernel_name = 'concat_heads__ssm_conv_s4d__mha_block__prompt'

def setup_inputs():

    _w = (lambda a: (lambda t: t.to(torch.bfloat16) if t.is_floating_point() else t)(torch.as_tensor(a)))
    def _A_setup():
        Bsz, L, D, N = 1, 2048, 512, 128
        return {
            "u": _w((lambda *s: torch.randn(*s, dtype=torch.bfloat16) * 0.05)(Bsz, L, D)),
            "log_A_real": _w((lambda *s: torch.randn(*s, dtype=torch.bfloat16) * 6.4)(D, N) * 0.5),
            "A_imag": _w((lambda *s: torch.randn(*s, dtype=torch.bfloat16) * 0.1)(D, N) * 3.14),
            "C_real": _w((lambda *s: torch.randn(*s, dtype=torch.bfloat16) * 0.4)(D, N) / N ** 0.5),
            "C_imag": _w((lambda *s: torch.randn(*s, dtype=torch.bfloat16) * 0.4)(D, N) / N ** 0.5),
            "log_dt": _w((lambda *s: torch.randn(*s, dtype=torch.bfloat16) * 0.1)(D) * 0.5 - 4.0),
            "D_skip": _w((lambda *s: torch.randn(*s, dtype=torch.bfloat16) * 0.1)(D)),
        }
    _A_in = _A_setup()

    def _B_setup():
        B, S, D, H = 1, 2048, 512, 32
        return {
            "x": _w((lambda *s: torch.randn(*s, dtype=torch.bfloat16) * 0.2)(B, S, D)),
            "wqkv": _w((lambda *s: torch.randn(*s, dtype=torch.bfloat16) * 0.2)(D, 3 * D)),
            "wo": _w((lambda *s: torch.randn(*s, dtype=torch.bfloat16) * 0.05)(D, D)),
        }
    _B_in = _B_setup()

    return {
        "A_u": _A_in["u"],
        "A_log_A_real": _A_in["log_A_real"],
        "A_A_imag": _A_in["A_imag"],
        "A_C_real": _A_in["C_real"],
        "A_C_imag": _A_in["C_imag"],
        "A_log_dt": _A_in["log_dt"],
        "A_D_skip": _A_in["D_skip"],
        "B_x": _B_in["x"],
        "B_wqkv": _B_in["wqkv"],
        "B_wo": _B_in["wo"],
    }

def reference(A_u, A_log_A_real, A_A_imag, A_C_real, A_C_imag, A_log_dt, A_D_skip, B_x, B_wqkv, B_wo):
    def _A_ref(u, log_A_real, A_imag, C_real, C_imag, log_dt, D_skip):
        L = u.shape[1]
        dt = torch.exp(log_dt)
        A = -torch.exp(log_A_real) + 1j * A_imag
        C = (C_real + 1j * C_imag) * dt[:, None]
        pos = (lambda x, dt: x.to(dt))(torch.arange(L), log_dt.dtype)
        P = torch.exp((A * dt[:, None])[:, :, None] * pos[None, None, :])
        K = 2.0 * torch.einsum("dn,dnl->dl", C, P).real
        L2 = 2 * L
        u_t = (lambda x, *d: x.permute(*d))(u, 0, 2, 1)
        Kf = (lambda x, *a, **k: torch.fft.rfft(x.float(), *a, **k))(K, L2)
        Uf = (lambda x, *a, **k: torch.fft.rfft(x.float(), *a, **k))(u_t, L2)
        y = (lambda x, *a, **k: torch.fft.irfft(x, *a, **k).to(torch.bfloat16))(Uf * Kf[None, :, :], L2)[:, :, :L]
        y = (lambda x, *d: x.permute(*d))(y, 0, 2, 1)
        return y + u * D_skip[None, None, :]

    def _B_ref(x, wqkv, wo):
        B, S, D = x.shape
        H = 32
        Dh = D // H
        qkv = (lambda x, *d: x.permute(*d))((x @ wqkv).reshape(B, S, 3, H, Dh), 2, 0, 3, 1, 4)
        q, k, v = qkv[0], qkv[1], qkv[2]
        scores = torch.einsum("bhqd,bhkd->bhqk", q, k) * (Dh ** -0.5)
        p = _softmax(scores, axis=-1)
        o = torch.einsum("bhqk,bhkd->bhqd", p, v)
        return (lambda x, *d: x.permute(*d))(o, 0, 2, 1, 3).reshape(B, S, D) @ wo

    a = _A_ref(A_u, A_log_A_real, A_A_imag, A_C_real, A_C_imag, A_log_dt, A_D_skip)
    b = _B_ref(B_x, B_wqkv, B_wo)
    return torch.concatenate([a, b], axis=-1)
```

```asm
; @launch grid=(256,1,1) block=(1024,1,1) lds=163840
.amdgcn_target "amdgcn-amd-amdhsa--gfx950"
.text
.globl concat_heads__ssm_conv_s4d__mha_block__prompt_kernel
.p2align 8
.type concat_heads__ssm_conv_s4d__mha_block__prompt_kernel,@function
concat_heads__ssm_conv_s4d__mha_block__prompt_kernel:
K_START:
    s_getpc_b64 s[4:5]
PF_PC:
    v_lshlrev_b32 v2, 7, v0
    v_cmp_gt_u32 vcc, GTAB_END-PF_PC-128, v2
    s_and_saveexec_b64 s[6:7], vcc
    s_cbranch_execz PF_DONE
    global_load_dword v127, v2, s[4:5]
PF_DONE:
    s_mov_b64 exec, s[6:7]
    s_cmp_ge_u32 s2, 256
    s_cbranch_scc1 K_END
    s_load_dwordx16 s[64:79], s[0:1], 0
    s_load_dwordx8 s[80:87], s[0:1], 64
    s_load_dwordx2 s[88:89], s[0:1], 96
    v_lshrrev_b32 v8, 6, v0
    v_and_b32 v0, 63, v0
    v_readfirstlane_b32 s3, v8
    v_lshlrev_b32 v1, 4, v0
    s_and_b32 s17, s2, 7
    s_lshr_b32 s18, s2, 3
    s_and_b32 s12, s17, 3
    s_lshl_b32 s12, s12, 2
    s_and_b32 s19, s18, 3
    s_add_u32 s12, s12, s19
    s_lshr_b32 s13, s17, 2
    s_lshl_b32 s13, s13, 3
    s_lshr_b32 s19, s18, 2
    s_add_u32 s13, s13, s19
    s_cmp_eq_u32 s3, 12
    s_cbranch_scc0 E_NZ
    v_lshlrev_b32 v20, 2, v0
    v_add_u32 v20, 147968, v20
    v_mov_b32 v24, 0
    ds_write_b32 v20, v24
E_NZ:
    s_cmp_ge_u32 s3, 12
    s_cbranch_scc0 E_NG
    s_sub_u32 s15, s3, 12
    s_setprio 3
    s_and_b32 s14, s2, 7
    s_lshl_b32 s14, s14, 5
    s_lshr_b32 s17, s2, 3
    s_add_u32 s14, s14, s17
    s_lshl_b32 s14, s14, 1
    s_lshl_b32 s17, s14, 8
    s_lshl_b32 s18, s15, 9
    s_mov_b32 s40, -1
    s_mov_b32 s41, 0
    v_lshrrev_b32 v14, 3, v0
    v_lshlrev_b32 v14, 10, v14
    v_and_b32 v13, 7, v0
    v_lshl_add_u32 v14, v13, 4, v14
    s_lshr_b32 s19, s2, 3
    s_lshl_b32 s19, s19, 16
    s_lshl_b32 s16, s15, 14
    s_add_u32 s19, s19, s16
    s_and_b32 s16, s2, 7
    s_lshl_b32 s16, s16, 7
    s_add_u32 s19, s19, s16
    v_lshrrev_b32 v12, 1, v0
    v_lshlrev_b32 v12, 10, v12
    v_and_b32 v13, 1, v0
    v_lshl_add_u32 v12, v13, 4, v12
    s_waitcnt lgkmcnt(0)
    s_mov_b32 s44, s88
    s_mov_b32 s45, s89
    s_mov_b32 s46, 12255232
    s_mov_b32 s47, 0x00020000
    s_mov_b32 s32, s66
    s_mov_b32 s33, s67
    s_cmp_eq_u32 s15, 1
    s_cselect_b32 s32, s68, s32
    s_cselect_b32 s33, s69, s33
    s_cmp_eq_u32 s15, 2
    s_cselect_b32 s32, s70, s32
    s_cselect_b32 s33, s71, s33
    s_cmp_eq_u32 s15, 3
    s_cselect_b32 s32, s72, s32
    s_cselect_b32 s33, s73, s33
    s_mov_b32 s34, 131072
    s_mov_b32 s35, 0x00020000
    s_add_u32 m0, s18, 57344
    s_mov_b64 exec, s[40:41]
    buffer_load_dwordx4 v1, s[32:35], s17 offen lds
    s_mov_b64 exec, -1
    s_and_b32 s20, s2, 7
    s_lshl_b32 s20, s20, 5
    s_lshr_b32 s21, s2, 3
    s_add_u32 s20, s20, s21
    s_lshl_b32 s20, s20, 1
    s_lshr_b32 s22, s15, 1
    s_and_b32 s24, s15, 1
    s_lshl_b32 s21, s20, 1
    s_add_u32 s28, s74, s21
    s_addc_u32 s29, s75, 0
    s_load_dword s26, s[28:29], 0
    s_add_u32 s30, s76, s21
    s_addc_u32 s31, s77, 0
    s_load_dword s27, s[30:31], 0
    s_getpc_b64 s[32:33]
KG_PC:
    s_add_u32 s32, s32, GTAB-KG_PC
    s_addc_u32 s33, s33, 0
    s_lshl_b32 s17, s15, 11
    v_lshlrev_b32 v11, 5, v0
    v_add_u32 v11, s17, v11
    global_load_dwordx4 v[96:99], v11, s[32:33]
    global_load_dwordx4 v[100:103], v11, s[32:33] offset:16
    s_mov_b32 s32, s64
    s_mov_b32 s33, s65
    s_mov_b32 s34, 2097152
    s_mov_b32 s35, 0x00020000
    s_add_u32 m0, s17, 61440
    s_nop 0
    buffer_load_dwordx4 v14, s[32:35], s19 offen lds
    s_add_u32 m0, s17, 62464
    s_add_u32 s19, s19, 8192
    buffer_load_dwordx4 v14, s[32:35], s19 offen lds
    s_mov_b32 s32, s82
    s_mov_b32 s33, s83
    s_mov_b32 s34, 524288
    s_mov_b32 s35, 0x00020000
    s_and_b32 s17, s2, 7
    s_lshl_b32 s17, s17, 16
    s_lshl_b32 s19, s15, 14
    s_add_u32 s17, s17, s19
    s_lshr_b32 s19, s2, 3
    s_lshl_b32 s19, s19, 5
    s_add_u32 s17, s17, s19
    s_add_u32 m0, s18, 59392
    s_mov_b64 exec, s[40:41]
    buffer_load_dwordx4 v12, s[32:35], s17 offen lds
    s_mov_b64 exec, -1
    s_cmp_eq_u32 s15, 0
    s_cbranch_scc0 KG_NE
    s_mov_b32 s16, 12124160
    v_mov_b32 v9, 0
    s_mov_b64 exec, 1
    buffer_load_dword v127, v9, s[44:47], s16 offen sc1
    s_mov_b64 exec, -1
KG_NE:
E_NG:
    s_waitcnt lgkmcnt(0)
    s_mov_b32 s44, s88
    s_mov_b32 s45, s89
    s_mov_b32 s46, 12255232
    s_mov_b32 s47, 0x00020000
    s_barrier
    s_cmp_lt_u32 s3, 4
    s_cbranch_scc1 R_COMPUTE
    s_cmp_ge_u32 s3, 12
    s_cbranch_scc1 R_KGEN
R_LOAD:
    s_sub_u32 s15, s3, 4
    s_setprio 3
    v_lshrrev_b32 v9, 3, v0
    v_lshrrev_b32 v10, 1, v9
    v_xor_b32 v10, v10, v0
    v_and_b32 v10, 7, v10
    v_lshlrev_b32 v10, 4, v10
    v_lshl_add_u32 v2, v9, 10, v10
    v_xor_b32 v3, 64, v2
    s_lshl_b32 s20, s12, 17
    s_lshl_b32 s17, s15, 14
    s_add_u32 s20, s20, s17
    s_lshl_b32 s21, s13, 6
    s_lshl_b32 s22, s15, 11
    s_lshl_b32 s23, s15, 10
    s_add_u32 s23, s23, 16384
    s_lshr_b32 s25, s2, 5
    s_lshr_b32 s17, s2, 3
    s_and_b32 s17, s17, 3
    s_lshl_b32 s17, s17, 1
    s_add_u32 s25, s25, s17
    s_waitcnt lgkmcnt(0)
    s_mov_b32 s4, s78
    s_mov_b32 s5, s79
    s_mov_b32 s6, 2097152
    s_mov_b32 s7, 0x00020000
    s_mov_b32 s8, s80
    s_mov_b32 s9, s81
    s_mov_b32 s10, 1572864
    s_mov_b32 s11, 0x00020000
    s_add_u32 s26, s25, 0
    s_and_b32 s26, s26, 7
    s_lshl_b32 s24, s26, 7
    s_add_u32 s24, s24, s20
    s_add_u32 m0, s22, 0
    s_mul_i32 s27, s26, 196608
    buffer_load_dwordx4 v2, s[4:7], s24 offen lds
    s_add_u32 m0, s22, 1024
    s_add_u32 s24, s24, 8192
    buffer_load_dwordx4 v3, s[4:7], s24 offen lds
    s_lshl_b32 s17, s15, 6
    s_movk_i32 s18, 3072
    s_mov_b32 s19, 43691
    v_add_u32 v9, s17, v0
    v_mul_u32_u24 v10, s19, v9
    v_lshrrev_b32 v10, 19, v10
    v_mul_u32_u24 v11, 12, v10
    v_sub_u32 v11, v9, v11
    v_lshrrev_b32 v12, 2, v10
    v_and_b32 v12, 2, v12
    v_xor_b32 v11, v11, v12
    v_lshrrev_b32 v12, 2, v11
    v_and_b32 v11, 3, v11
    v_lshlrev_b32 v11, 4, v11
    v_lshl_add_u32 v11, v12, 10, v11
    v_mad_u32_u24 v5, v10, s18, v11
    v_add_u32 v9, s17, v0
    v_add_u32 v9, 512, v9
    v_mul_u32_u24 v10, s19, v9
    v_lshrrev_b32 v10, 19, v10
    v_mul_u32_u24 v11, 12, v10
    v_sub_u32 v11, v9, v11
    v_lshrrev_b32 v12, 2, v10
    v_and_b32 v12, 2, v12
    v_xor_b32 v11, v11, v12
    v_lshrrev_b32 v12, 2, v11
    v_and_b32 v11, 3, v11
    v_lshlrev_b32 v11, 4, v11
    v_lshl_add_u32 v11, v12, 10, v11
    v_mad_u32_u24 v6, v10, s18, v11
    s_cmp_ge_u32 s15, 4
    s_cbranch_scc1 P1_LOADER1
    s_add_u32 m0, s23, 0
    s_add_u32 s27, s27, s21
    buffer_load_dwordx4 v5, s[8:11], s27 offen lds
    s_add_u32 m0, s23, 8192
    s_nop 0
    buffer_load_dwordx4 v6, s[8:11], s27 offen lds
    s_add_u32 s26, s25, 1
    s_and_b32 s26, s26, 7
    s_lshl_b32 s24, s26, 7
    s_add_u32 s24, s24, s20
    s_add_u32 m0, s22, 28672
    s_mul_i32 s27, s26, 196608
    buffer_load_dwordx4 v2, s[4:7], s24 offen lds
    s_add_u32 m0, s22, 29696
    s_add_u32 s24, s24, 8192
    buffer_load_dwordx4 v3, s[4:7], s24 offen lds
    s_add_u32 m0, s23, 28672
    s_add_u32 s27, s27, s21
    buffer_load_dwordx4 v5, s[8:11], s27 offen lds
    s_add_u32 m0, s23, 36864
    s_nop 0
    buffer_load_dwordx4 v6, s[8:11], s27 offen lds
    s_waitcnt vmcnt(4)
    s_barrier
    s_add_u32 s26, s25, 2
    s_and_b32 s26, s26, 7
    s_lshl_b32 s24, s26, 7
    s_add_u32 s24, s24, s20
    s_add_u32 m0, s22, 57344
    s_mul_i32 s27, s26, 196608
    buffer_load_dwordx4 v2, s[4:7], s24 offen lds
    s_add_u32 m0, s22, 58368
    s_add_u32 s24, s24, 8192
    buffer_load_dwordx4 v3, s[4:7], s24 offen lds
    s_add_u32 m0, s23, 57344
    s_add_u32 s27, s27, s21
    buffer_load_dwordx4 v5, s[8:11], s27 offen lds
    s_add_u32 m0, s23, 65536
    s_nop 0
    buffer_load_dwordx4 v6, s[8:11], s27 offen lds
    s_waitcnt vmcnt(4)
    s_barrier
    s_add_u32 s26, s25, 3
    s_and_b32 s26, s26, 7
    s_lshl_b32 s24, s26, 7
    s_add_u32 s24, s24, s20
    s_add_u32 m0, s22, 0
    s_mul_i32 s27, s26, 196608
    buffer_load_dwordx4 v2, s[4:7], s24 offen lds
    s_add_u32 m0, s22, 1024
    s_add_u32 s24, s24, 8192
    buffer_load_dwordx4 v3, s[4:7], s24 offen lds
    s_add_u32 m0, s23, 0
    s_add_u32 s27, s27, s21
    buffer_load_dwordx4 v5, s[8:11], s27 offen lds
    s_add_u32 m0, s23, 8192
    s_nop 0
    buffer_load_dwordx4 v6, s[8:11], s27 offen lds
    s_waitcnt vmcnt(4)
    s_barrier
    s_add_u32 s26, s25, 4
    s_and_b32 s26, s26, 7
    s_lshl_b32 s24, s26, 7
    s_add_u32 s24, s24, s20
    s_add_u32 m0, s22, 28672
    s_mul_i32 s27, s26, 196608
    buffer_load_dwordx4 v2, s[4:7], s24 offen lds
    s_add_u32 m0, s22, 29696
    s_add_u32 s24, s24, 8192
    buffer_load_dwordx4 v3, s[4:7], s24 offen lds
    s_add_u32 m0, s23, 28672
    s_add_u32 s27, s27, s21
    buffer_load_dwordx4 v5, s[8:11], s27 offen lds
    s_add_u32 m0, s23, 36864
    s_nop 0
    buffer_load_dwordx4 v6, s[8:11], s27 offen lds
    s_waitcnt vmcnt(4)
    s_barrier
    s_add_u32 s26, s25, 5
    s_and_b32 s26, s26, 7
    s_lshl_b32 s24, s26, 7
    s_add_u32 s24, s24, s20
    s_add_u32 m0, s22, 57344
    s_mul_i32 s27, s26, 196608
    buffer_load_dwordx4 v2, s[4:7], s24 offen lds
    s_add_u32 m0, s22, 58368
    s_add_u32 s24, s24, 8192
    buffer_load_dwordx4 v3, s[4:7], s24 offen lds
    s_add_u32 m0, s23, 57344
    s_add_u32 s27, s27, s21
    buffer_load_dwordx4 v5, s[8:11], s27 offen lds
    s_add_u32 m0, s23, 65536
    s_nop 0
    buffer_load_dwordx4 v6, s[8:11], s27 offen lds
    s_waitcnt vmcnt(4)
    s_barrier
    s_add_u32 s26, s25, 6
    s_and_b32 s26, s26, 7
    s_lshl_b32 s24, s26, 7
    s_add_u32 s24, s24, s20
    s_add_u32 m0, s22, 0
    s_mul_i32 s27, s26, 196608
    buffer_load_dwordx4 v2, s[4:7], s24 offen lds
    s_add_u32 m0, s22, 1024
    s_add_u32 s24, s24, 8192
    buffer_load_dwordx4 v3, s[4:7], s24 offen lds
    s_add_u32 m0, s23, 0
    s_add_u32 s27, s27, s21
    buffer_load_dwordx4 v5, s[8:11], s27 offen lds
    s_add_u32 m0, s23, 8192
    s_nop 0
    buffer_load_dwordx4 v6, s[8:11], s27 offen lds
    s_waitcnt vmcnt(4)
    s_barrier
    s_add_u32 s26, s25, 7
    s_and_b32 s26, s26, 7
    s_lshl_b32 s24, s26, 7
    s_add_u32 s24, s24, s20
    s_add_u32 m0, s22, 28672
    s_mul_i32 s27, s26, 196608
    buffer_load_dwordx4 v2, s[4:7], s24 offen lds
    s_add_u32 m0, s22, 29696
    s_add_u32 s24, s24, 8192
    buffer_load_dwordx4 v3, s[4:7], s24 offen lds
    s_add_u32 m0, s23, 28672
    s_add_u32 s27, s27, s21
    buffer_load_dwordx4 v5, s[8:11], s27 offen lds
    s_add_u32 m0, s23, 36864
    s_nop 0
    buffer_load_dwordx4 v6, s[8:11], s27 offen lds
    s_and_b32 s14, s2, 7
    s_lshl_b32 s14, s14, 5
    s_lshr_b32 s17, s2, 3
    s_add_u32 s14, s14, s17
    s_lshl_b32 s14, s14, 1
    s_lshr_b32 s16, s15, 2
    s_add_u32 s17, s14, s16
    s_lshl_b32 s17, s17, 12
    s_add_u32 s17, s17, 8388608
    s_waitcnt lgkmcnt(0)
    s_mov_b32 s44, s88
    s_mov_b32 s45, s89
    s_mov_b32 s46, 12255232
    s_mov_b32 s47, 0x00020000
    s_add_u32 s32, s88, s17
    s_addc_u32 s33, s89, 0
    s_mov_b32 s34, 4096
    s_mov_b32 s35, 0x00020000
    s_and_b32 s19, s15, 3
    s_lshl_b32 s19, s19, 10
    v_add_u32 v116, s19, v1
    v_subrev_u32 v117, 16, v116
    v_cmp_eq_u32 vcc, 0, v116
    v_mov_b32 v118, 4096
    s_nop 0
    v_cndmask_b32 v117, v117, v118, vcc
    v_mov_b32 v119, 4096
    v_mov_b32 v120, 4080
    v_cmp_eq_u32 vcc, 3, v0
    s_nop 1
    v_cndmask_b32 v119, v119, v120, vcc
    s_waitcnt vmcnt(4)
    s_barrier
    v_mov_b32 v30, 148048
    ds_read_b32 v31, v30
    s_waitcnt lgkmcnt(0)
    v_readfirstlane_b32 s40, v31
    s_nop 0
    s_cmp_eq_u32 s40, 0
    s_cbranch_scc1 CVC_1
    buffer_load_dwordx4 v[108:111], v117, s[32:35], 0 offen sc1
    buffer_load_dwordx4 v[112:115], v116, s[32:35], 0 offen sc1
    buffer_load_dwordx4 v[120:123], v119, s[32:35], 0 offen sc1
    s_waitcnt vmcnt(3)
    s_branch CVC_1b
CVC_1:
    s_waitcnt vmcnt(0)
CVC_1b:
    s_barrier
    s_branch P1_LOADER_END
P1_LOADER1:
    s_add_u32 m0, s23, 0
    s_add_u32 s27, s27, s21
    buffer_load_dwordx4 v5, s[8:11], s27 offen lds
    s_add_u32 s26, s25, 1
    s_and_b32 s26, s26, 7
    s_lshl_b32 s24, s26, 7
    s_add_u32 s24, s24, s20
    s_add_u32 m0, s22, 28672
    s_mul_i32 s27, s26, 196608
    buffer_load_dwordx4 v2, s[4:7], s24 offen lds
    s_add_u32 m0, s22, 29696
    s_add_u32 s24, s24, 8192
    buffer_load_dwordx4 v3, s[4:7], s24 offen lds
    s_add_u32 m0, s23, 28672
    s_add_u32 s27, s27, s21
    buffer_load_dwordx4 v5, s[8:11], s27 offen lds
    s_waitcnt vmcnt(3)
    s_barrier
    s_add_u32 s26, s25, 2
    s_and_b32 s26, s26, 7
    s_lshl_b32 s24, s26, 7
    s_add_u32 s24, s24, s20
    s_add_u32 m0, s22, 57344
    s_mul_i32 s27, s26, 196608
    buffer_load_dwordx4 v2, s[4:7], s24 offen lds
    s_add_u32 m0, s22, 58368
    s_add_u32 s24, s24, 8192
    buffer_load_dwordx4 v3, s[4:7], s24 offen lds
    s_add_u32 m0, s23, 57344
    s_add_u32 s27, s27, s21
    buffer_load_dwordx4 v5, s[8:11], s27 offen lds
    s_waitcnt vmcnt(3)
    s_barrier
    s_add_u32 s26, s25, 3
    s_and_b32 s26, s26, 7
    s_lshl_b32 s24, s26, 7
    s_add_u32 s24, s24, s20
    s_add_u32 m0, s22, 0
    s_mul_i32 s27, s26, 196608
    buffer_load_dwordx4 v2, s[4:7], s24 offen lds
    s_add_u32 m0, s22, 1024
    s_add_u32 s24, s24, 8192
    buffer_load_dwordx4 v3, s[4:7], s24 offen lds
    s_add_u32 m0, s23, 0
    s_add_u32 s27, s27, s21
    buffer_load_dwordx4 v5, s[8:11], s27 offen lds
    s_waitcnt vmcnt(3)
    s_barrier
    s_add_u32 s26, s25, 4
    s_and_b32 s26, s26, 7
    s_lshl_b32 s24, s26, 7
    s_add_u32 s24, s24, s20
    s_add_u32 m0, s22, 28672
    s_mul_i32 s27, s26, 196608
    buffer_load_dwordx4 v2, s[4:7], s24 offen lds
    s_add_u32 m0, s22, 29696
    s_add_u32 s24, s24, 8192
    buffer_load_dwordx4 v3, s[4:7], s24 offen lds
    s_add_u32 m0, s23, 28672
    s_add_u32 s27, s27, s21
    buffer_load_dwordx4 v5, s[8:11], s27 offen lds
    s_waitcnt vmcnt(3)
    s_barrier
    s_add_u32 s26, s25, 5
    s_and_b32 s26, s26, 7
    s_lshl_b32 s24, s26, 7
    s_add_u32 s24, s24, s20
    s_add_u32 m0, s22, 57344
    s_mul_i32 s27, s26, 196608
    buffer_load_dwordx4 v2, s[4:7], s24 offen lds
    s_add_u32 m0, s22, 58368
    s_add_u32 s24, s24, 8192
    buffer_load_dwordx4 v3, s[4:7], s24 offen lds
    s_add_u32 m0, s23, 57344
    s_add_u32 s27, s27, s21
    buffer_load_dwordx4 v5, s[8:11], s27 offen lds
    s_waitcnt vmcnt(3)
    s_barrier
    s_add_u32 s26, s25, 6
    s_and_b32 s26, s26, 7
    s_lshl_b32 s24, s26, 7
    s_add_u32 s24, s24, s20
    s_add_u32 m0, s22, 0
    s_mul_i32 s27, s26, 196608
    buffer_load_dwordx4 v2, s[4:7], s24 offen lds
    s_add_u32 m0, s22, 1024
    s_add_u32 s24, s24, 8192
    buffer_load_dwordx4 v3, s[4:7], s24 offen lds
    s_add_u32 m0, s23, 0
    s_add_u32 s27, s27, s21
    buffer_load_dwordx4 v5, s[8:11], s27 offen lds
    s_waitcnt vmcnt(3)
    s_barrier
    s_add_u32 s26, s25, 7
    s_and_b32 s26, s26, 7
    s_lshl_b32 s24, s26, 7
    s_add_u32 s24, s24, s20
    s_add_u32 m0, s22, 28672
    s_mul_i32 s27, s26, 196608
    buffer_load_dwordx4 v2, s[4:7], s24 offen lds
    s_add_u32 m0, s22, 29696
    s_add_u32 s24, s24, 8192
    buffer_load_dwordx4 v3, s[4:7], s24 offen lds
    s_add_u32 m0, s23, 28672
    s_add_u32 s27, s27, s21
    buffer_load_dwordx4 v5, s[8:11], s27 offen lds
    s_and_b32 s14, s2, 7
    s_lshl_b32 s14, s14, 5
    s_lshr_b32 s17, s2, 3
    s_add_u32 s14, s14, s17
    s_lshl_b32 s14, s14, 1
    s_lshr_b32 s16, s15, 2
    s_add_u32 s17, s14, s16
    s_lshl_b32 s17, s17, 12
    s_add_u32 s17, s17, 8388608
    s_waitcnt lgkmcnt(0)
    s_mov_b32 s44, s88
    s_mov_b32 s45, s89
    s_mov_b32 s46, 12255232
    s_mov_b32 s47, 0x00020000
    s_add_u32 s32, s88, s17
    s_addc_u32 s33, s89, 0
    s_mov_b32 s34, 4096
    s_mov_b32 s35, 0x00020000
    s_and_b32 s19, s15, 3
    s_lshl_b32 s19, s19, 10
    v_add_u32 v116, s19, v1
    v_subrev_u32 v117, 16, v116
    v_cmp_eq_u32 vcc, 0, v116
    v_mov_b32 v118, 4096
    s_nop 0
    v_cndmask_b32 v117, v117, v118, vcc
    v_mov_b32 v119, 4096
    v_mov_b32 v120, 4080
    v_cmp_eq_u32 vcc, 3, v0
    s_nop 1
    v_cndmask_b32 v119, v119, v120, vcc
    s_waitcnt vmcnt(3)
    s_barrier
    v_mov_b32 v30, 148048
    ds_read_b32 v31, v30
    s_waitcnt lgkmcnt(0)
    v_readfirstlane_b32 s40, v31
    s_nop 0
    s_cmp_eq_u32 s40, 0
    s_cbranch_scc1 CVC_2
    buffer_load_dwordx4 v[108:111], v117, s[32:35], 0 offen sc1
    buffer_load_dwordx4 v[112:115], v116, s[32:35], 0 offen sc1
    buffer_load_dwordx4 v[120:123], v119, s[32:35], 0 offen sc1
    s_waitcnt vmcnt(3)
    s_branch CVC_2b
CVC_2:
    s_waitcnt vmcnt(0)
CVC_2b:
    s_barrier
P1_LOADER_END:
    s_setprio 1
    s_cmp_lg_u32 s40, 0
    s_cbranch_scc1 CV_HAVE
    v_mov_b32 v72, 148048
    s_mov_b32 s43, 0
LW_3:
    ds_read_b32 v73, v72
    s_add_u32 s43, s43, 1
    s_waitcnt lgkmcnt(0)
    v_readfirstlane_b32 s42, v73
    s_cmp_gt_u32 s43, 0x80000
    s_cbranch_scc1 LW_3_x
    s_cmp_ge_u32 s42, 1
    s_cbranch_scc1 LW_3_x
    s_sleep 1
    s_branch LW_3
LW_3_x:
    buffer_load_dwordx4 v[108:111], v117, s[32:35], 0 offen sc1
    buffer_load_dwordx4 v[112:115], v116, s[32:35], 0 offen sc1
    buffer_load_dwordx4 v[120:123], v119, s[32:35], 0 offen sc1
CV_HAVE:
    v_mov_b32 v30, 148064
    s_mov_b32 s43, 0
GT_4:
    ds_read_b32 v127, v30
    s_add_u32 s43, s43, 1
    s_waitcnt lgkmcnt(0)
    v_readfirstlane_b32 s90, v127
    s_cmp_gt_u32 s43, 0x80000
    s_cbranch_scc1 GT_4_x
    s_cmp_eq_u32 s90, 0
    s_cbranch_scc1 GT_4
GT_4_x:
    s_lshr_b32 s16, s15, 2
    s_mul_i32 s21, s16, 16640
    s_add_u32 s21, s21, 57392
    v_add_u32 v19, s21, v116
    s_mul_i32 s23, s16, 7680
    s_add_u32 s23, s23, 148480
    v_and_b32 v9, 31, v0
    v_lshrrev_b32 v10, 5, v0
    v_and_b32 v11, 3, v9
    v_mul_u32_u24 v11, 4160, v11
    v_lshrrev_b32 v12, 2, v9
    v_lshl_add_u32 v11, v12, 3, v11
    v_lshl_add_u32 v11, v10, 4, v11
    s_mul_i32 s24, s16, 16640
    s_add_u32 s24, s24, 57344
    v_add_u32 v4, s24, v11
    v_sub_u32 v11, 63, v9
    v_mul_u32_u24 v11, 80, v11
    v_lshl_add_u32 v11, v10, 4, v11
    v_add_u32 v5, s23, v11
    v_subrev_u32 v6, 2560, v5
    s_and_b32 s24, s15, 3
    s_mul_i32 s25, s16, 28672
    s_lshl_b32 s26, s24, 12
    s_add_u32 s25, s25, s26
    s_add_u32 s25, s25, 90624
    v_add_u32 v7, s25, v1
    s_mul_i32 s26, s24, 24
    s_cmp_eq_u32 s24, 3
    s_cselect_b32 s26, 80, s26
    s_cmp_ge_u32 s24, 2
    s_cselect_b32 s28, 4, 6
    s_cmp_eq_u32 s24, 3
    s_cselect_b32 s28, 0, s28
    s_cmp_eq_u32 s24, 2
    s_cselect_b32 s29, 4, 0
    s_cmp_eq_u32 s24, 3
    s_cselect_b32 s29, 12, s29
    s_lshl_b32 s27, s26, 5
    v_add_u32 v4, s27, v4
    s_mul_i32 s27, s26, 40
    v_add_u32 v5, s27, v5
    v_add_u32 v6, s27, v6
    s_waitcnt vmcnt(0)
    v_alignbit_b32 v44, v109, v108, 16
    v_alignbit_b32 v45, v110, v109, 16
    v_alignbit_b32 v46, v111, v110, 16
    v_alignbit_b32 v47, v112, v111, 16
    v_mov_b32 v48, v109
    v_mov_b32 v49, v110
    v_mov_b32 v50, v111
    v_mov_b32 v51, v112
    v_alignbit_b32 v52, v110, v109, 16
    v_alignbit_b32 v53, v111, v110, 16
    v_alignbit_b32 v54, v112, v111, 16
    v_alignbit_b32 v55, v113, v112, 16
    ds_write_b128 v19, v[44:47]
    ds_write_b128 v19, v[48:51] offset:4160
    ds_write_b128 v19, v[52:55] offset:8320
    ds_write_b128 v19, v[110:113] offset:12480
    s_cmp_eq_u32 s19, 0
    s_cbranch_scc0 CV_NOX2
    v_mov_b32 v56, v120
    v_mov_b32 v57, v121
    v_mov_b32 v58, v122
    v_mov_b32 v59, v123
    v_mov_b32 v60, 0
    v_mov_b32 v61, 0
    v_mov_b32 v62, 0
    v_mov_b32 v63, 0
    v_mov_b32 v30, 4144
    v_cmp_eq_u32 vcc, 3, v0
    s_sub_u32 s21, s21, 48
    v_cndmask_b32 v30, v1, v30, vcc
    v_add_u32 v30, s21, v30
    s_mov_b64 exec, 15
    v_alignbit_b32 v44, v57, v56, 16
    v_alignbit_b32 v45, v58, v57, 16
    v_alignbit_b32 v46, v59, v58, 16
    v_alignbit_b32 v47, v60, v59, 16
    v_mov_b32 v48, v57
    v_mov_b32 v49, v58
    v_mov_b32 v50, v59
    v_mov_b32 v51, v60
    v_alignbit_b32 v52, v58, v57, 16
    v_alignbit_b32 v53, v59, v58, 16
    v_alignbit_b32 v54, v60, v59, 16
    v_alignbit_b32 v55, v61, v60, 16
    ds_write_b128 v30, v[44:47]
    ds_write_b128 v30, v[48:51] offset:4160
    ds_write_b128 v30, v[52:55] offset:8320
    ds_write_b128 v30, v[58:61] offset:12480
    s_mov_b64 exec, -1
CV_NOX2:
    v_mov_b32 v56, 0
    v_mov_b32 v57, 0
    v_mov_b32 v58, 0
    v_mov_b32 v59, 0
    v_mov_b32 v60, 0
    v_mov_b32 v61, 0
    v_mov_b32 v62, 0
    v_mov_b32 v63, 0
    v_mov_b32 v64, 0
    v_mov_b32 v65, 0
    v_mov_b32 v66, 0
    v_mov_b32 v67, 0
    v_mov_b32 v68, 0
    v_mov_b32 v69, 0
    v_mov_b32 v70, 0
    v_mov_b32 v71, 0
    v_mov_b32 v72, 0
    v_mov_b32 v73, 0
    v_mov_b32 v74, 0
    v_mov_b32 v75, 0
    v_mov_b32 v76, 0
    v_mov_b32 v77, 0
    v_mov_b32 v78, 0
    v_mov_b32 v79, 0
    v_mov_b32 v80, 0
    v_mov_b32 v81, 0
    v_mov_b32 v82, 0
    v_mov_b32 v83, 0
    v_mov_b32 v84, 0
    v_mov_b32 v85, 0
    v_mov_b32 v86, 0
    v_mov_b32 v87, 0
    s_waitcnt lgkmcnt(0)
    v_mov_b32 v8, 147972
    v_mov_b32 v9, 1
    s_mov_b64 exec, 1
    ds_add_u32 v8, v9
    s_mov_b64 exec, -1
    v_mov_b32 v8, 147972
    s_mov_b32 s43, 0
LW_5:
    ds_read_b32 v9, v8
    s_add_u32 s43, s43, 1
    s_waitcnt lgkmcnt(0)
    v_readfirstlane_b32 s42, v9
    s_cmp_gt_u32 s43, 0x80000
    s_cbranch_scc1 LW_5_x
    s_cmp_ge_u32 s42, 8
    s_cbranch_scc0 LW_5
LW_5_x:
    ds_read_b64 v[8:9], v4 offset:0
    ds_read_b64 v[10:11], v4 offset:8
    ds_read_b128 v[40:43], v6 offset:0
    ds_read_b128 v[24:27], v5 offset:0
    ds_read_b64 v[12:13], v4 offset:32
    ds_read_b64 v[14:15], v4 offset:40
    ds_read_b128 v[44:47], v6 offset:32
    ds_read_b128 v[28:31], v5 offset:32
    ds_read_b64 v[16:17], v4 offset:64
    ds_read_b64 v[18:19], v4 offset:72
    ds_read_b128 v[48:51], v6 offset:80
    ds_read_b128 v[32:35], v5 offset:80
    s_cmp_eq_u32 s28, 0
    s_cbranch_scc1 CV_SL0
CV_DL:
    s_waitcnt lgkmcnt(9)
    v_mfma_f32_32x32x16_bf16 v[72:87], v[8:11], v[40:43], v[72:87]
    ds_read_b64 v[20:21], v4 offset:96
    ds_read_b64 v[22:23], v4 offset:104
    s_waitcnt lgkmcnt(10)
    v_mfma_f32_32x32x16_bf16 v[56:71], v[8:11], v[24:27], v[56:71]
    ds_read_b128 v[52:55], v6 offset:112
    ds_read_b128 v[36:39], v5 offset:112
    s_waitcnt lgkmcnt(9)
    v_mfma_f32_32x32x16_bf16 v[72:87], v[12:15], v[44:47], v[72:87]
    ds_read_b64 v[8:9], v4 offset:128
    ds_read_b64 v[10:11], v4 offset:136
    s_waitcnt lgkmcnt(10)
    v_mfma_f32_32x32x16_bf16 v[56:71], v[12:15], v[28:31], v[56:71]
    ds_read_b128 v[40:43], v6 offset:160
    ds_read_b128 v[24:27], v5 offset:160
    s_waitcnt lgkmcnt(9)
    v_mfma_f32_32x32x16_bf16 v[72:87], v[16:19], v[48:51], v[72:87]
    ds_read_b64 v[12:13], v4 offset:160
    ds_read_b64 v[14:15], v4 offset:168
    s_waitcnt lgkmcnt(10)
    v_mfma_f32_32x32x16_bf16 v[56:71], v[16:19], v[32:35], v[56:71]
    ds_read_b128 v[44:47], v6 offset:192
    ds_read_b128 v[28:31], v5 offset:192
    s_waitcnt lgkmcnt(9)
    v_mfma_f32_32x32x16_bf16 v[72:87], v[20:23], v[52:55], v[72:87]
    ds_read_b64 v[16:17], v4 offset:192
    ds_read_b64 v[18:19], v4 offset:200
    s_waitcnt lgkmcnt(10)
    v_mfma_f32_32x32x16_bf16 v[56:71], v[20:23], v[36:39], v[56:71]
    ds_read_b128 v[48:51], v6 offset:240
    ds_read_b128 v[32:35], v5 offset:240
    v_add_u32 v4, 128, v4
    v_add_u32 v5, 160, v5
    v_add_u32 v6, 160, v6
    s_sub_u32 s28, s28, 1
    s_cmp_lg_u32 s28, 0
    s_cbranch_scc1 CV_DL
CV_SL0:
    s_cmp_eq_u32 s29, 0
    s_cbranch_scc1 CV_DONE
CV_SL:
    s_waitcnt lgkmcnt(6)
    v_mfma_f32_32x32x16_bf16 v[72:87], v[8:11], v[40:43], v[72:87]
    ds_read_b64 v[20:21], v4 offset:96
    ds_read_b64 v[22:23], v4 offset:104
    ds_read_b128 v[52:55], v6 offset:112
    s_waitcnt lgkmcnt(6)
    v_mfma_f32_32x32x16_bf16 v[72:87], v[12:15], v[44:47], v[72:87]
    ds_read_b64 v[8:9], v4 offset:128
    ds_read_b64 v[10:11], v4 offset:136
    ds_read_b128 v[40:43], v6 offset:160
    s_waitcnt lgkmcnt(6)
    v_mfma_f32_32x32x16_bf16 v[72:87], v[16:19], v[48:51], v[72:87]
    ds_read_b64 v[12:13], v4 offset:160
    ds_read_b64 v[14:15], v4 offset:168
    ds_read_b128 v[44:47], v6 offset:192
    s_waitcnt lgkmcnt(6)
    v_mfma_f32_32x32x16_bf16 v[72:87], v[20:23], v[52:55], v[72:87]
    ds_read_b64 v[16:17], v4 offset:192
    ds_read_b64 v[18:19], v4 offset:200
    ds_read_b128 v[48:51], v6 offset:240
    v_add_u32 v4, 128, v4
    v_add_u32 v6, 160, v6
    s_sub_u32 s29, s29, 1
    s_cmp_lg_u32 s29, 0
    s_cbranch_scc1 CV_SL
CV_DONE:
    s_waitcnt lgkmcnt(0)
    s_nop 15
    ds_write_b128 v7, v[72:75] offset:0
    ds_write_b128 v7, v[76:79] offset:1024
    ds_write_b128 v7, v[80:83] offset:2048
    ds_write_b128 v7, v[84:87] offset:3072
    s_cmp_eq_u32 s24, 3
    s_cbranch_scc1 CV_PE
    ds_write_b128 v7, v[56:59] offset:16384
    ds_write_b128 v7, v[60:63] offset:17408
    ds_write_b128 v7, v[64:67] offset:18432
    ds_write_b128 v7, v[68:71] offset:19456
CV_PE:
    s_waitcnt lgkmcnt(0)
    v_mov_b32 v8, 147972
    v_mov_b32 v9, 1
    s_mov_b64 exec, 1
    ds_add_u32 v8, v9
    s_mov_b64 exec, -1
    v_mov_b32 v8, 147972
    s_mov_b32 s43, 0
LW_6:
    ds_read_b32 v9, v8
    s_add_u32 s43, s43, 1
    s_waitcnt lgkmcnt(0)
    v_readfirstlane_b32 s42, v9
    s_cmp_gt_u32 s43, 0x80000
    s_cbranch_scc1 LW_6_x
    s_cmp_ge_u32 s42, 16
    s_cbranch_scc0 LW_6
LW_6_x:
    s_lshl_b32 s26, s24, 10
    s_add_u32 s26, s26, 90624
    v_add_u32 v4, s26, v1
    s_cmp_eq_u32 s16, 0
    s_cbranch_scc1 CV_F0
    ds_read_b128 v[16:19], v4 offset:0
    ds_read_b128 v[20:23], v4 offset:4096
    ds_read_b128 v[24:27], v4 offset:8192
    ds_read_b128 v[28:31], v4 offset:12288
    ds_read_b128 v[32:35], v4 offset:28672
    ds_read_b128 v[36:39], v4 offset:32768
    ds_read_b128 v[40:43], v4 offset:36864
    ds_read_b128 v[44:47], v4 offset:40960
    s_waitcnt lgkmcnt(0)
    v_add_f32 v16, v16, v20
    v_add_f32 v24, v24, v28
    v_add_f32 v17, v17, v21
    v_add_f32 v25, v25, v29
    v_add_f32 v18, v18, v22
    v_add_f32 v26, v26, v30
    v_add_f32 v19, v19, v23
    v_add_f32 v27, v27, v31
    v_add_f32 v16, v16, v24
    v_add_f32 v17, v17, v25
    v_add_f32 v18, v18, v26
    v_add_f32 v19, v19, v27
    v_add_f32 v32, v32, v36
    v_add_f32 v40, v40, v44
    v_add_f32 v33, v33, v37
    v_add_f32 v41, v41, v45
    v_add_f32 v34, v34, v38
    v_add_f32 v42, v42, v46
    v_add_f32 v35, v35, v39
    v_add_f32 v43, v43, v47
    v_add_f32 v32, v32, v40
    v_add_f32 v33, v33, v41
    v_add_f32 v34, v34, v42
    v_add_f32 v35, v35, v43
    s_branch CV_F1
CV_F0:
    ds_read_b128 v[16:19], v4 offset:16384
    ds_read_b128 v[20:23], v4 offset:20480
    ds_read_b128 v[24:27], v4 offset:24576
    ds_read_b128 v[32:35], v4 offset:45056
    ds_read_b128 v[36:39], v4 offset:49152
    ds_read_b128 v[40:43], v4 offset:53248
    s_waitcnt lgkmcnt(0)
    v_add_f32 v16, v16, v20
    v_add_f32 v17, v17, v21
    v_add_f32 v18, v18, v22
    v_add_f32 v19, v19, v23
    v_add_f32 v16, v16, v24
    v_add_f32 v17, v17, v25
    v_add_f32 v18, v18, v26
    v_add_f32 v19, v19, v27
    v_add_f32 v32, v32, v36
    v_add_f32 v33, v33, v37
    v_add_f32 v34, v34, v38
    v_add_f32 v35, v35, v39
    v_add_f32 v32, v32, v40
    v_add_f32 v33, v33, v41
    v_add_f32 v34, v34, v42
    v_add_f32 v35, v35, v43
CV_F1:
    v_cvt_pk_bf16_f32 v90, v16, v32
    v_cvt_pk_bf16_f32 v91, v17, v33
    v_cvt_pk_bf16_f32 v126, v18, v34
    v_cvt_pk_bf16_f32 v127, v19, v35
    s_lshl_b32 s36, s16, 21
    s_lshl_b32 s25, s24, 14
    s_add_u32 s36, s36, s25
    s_lshl_b32 s25, s14, 1
    s_add_u32 s36, s36, s25
    s_setprio 0
    s_and_b32 s12, s2, 7
    s_lshl_b32 s12, s12, 2
    s_lshr_b32 s13, s2, 3
    s_and_b32 s17, s13, 3
    s_add_u32 s12, s12, s17
    s_lshr_b32 s13, s2, 5
    s_lshl_b32 s17, s12, 16
    s_mov_b32 s20, 0x0000ffff
    s_mov_b32 s21, 0x0000ffff
    s_and_b32 s15, s3, 7
    s_lshr_b32 s16, s3, 3
    s_lshl_b32 s19, s16, 10
    v_add_u32 v2, s19, v1
    v_lshrrev_b32 v8, 5, v0
    v_lshlrev_b32 v8, 8, v8
    v_and_b32 v9, 15, v0
    v_lshlrev_b32 v9, 4, v9
    s_add_u32 s19, s19, 2048
    v_add3_u32 v3, v8, v9, s19
    v_and_b32 v8, 31, v0
    v_cmp_eq_u32 vcc, 16, v8
    v_mov_b32 v9, 0x3f803f80
    s_lshl_b32 s22, s15, 10
    s_add_u32 s22, s22, 49152
    v_cndmask_b32 v9, 0, v9, vcc
    v_add_u32 v4, s22, v1
    v_mov_b32 v16, v9
    v_mov_b32 v17, v9
    v_mov_b32 v18, v9
    v_mov_b32 v19, v9
    v_mov_b32 v20, v9
    v_mov_b32 v21, v9
    v_mov_b32 v22, v9
    v_mov_b32 v23, v9
    v_mov_b32 v24, v9
    v_mov_b32 v25, v9
    v_mov_b32 v26, v9
    v_mov_b32 v27, v9
    v_mov_b32 v28, v9
    v_mov_b32 v29, v9
    v_mov_b32 v30, v9
    v_mov_b32 v31, v9
    v_mov_b32 v88, 0
    s_lshl_b32 s18, s13, 3
    s_add_u32 s18, s18, s15
    s_lshl_b32 s19, s18, 13
    s_lshl_b32 s22, s12, 8
    s_add_u32 s19, s19, s22
    s_add_u32 s19, s19, 11272192
    s_lshl_b32 s18, s18, 10
    s_add_u32 s18, s18, s17
    s_lshr_b32 s22, s3, 2
    s_and_b32 s23, s3, 3
    s_lshl_b32 s24, s23, 12
    s_lshl_b32 s26, s22, 10
    s_add_u32 s24, s24, s26
    v_add_u32 v124, s24, v1
    s_and_b32 s25, s22, 1
    s_lshl_b32 s25, s25, 15
    s_lshr_b32 s26, s22, 1
    s_lshl_b32 s26, s26, 21
    s_add_u32 s25, s25, s26
    s_lshl_b32 s23, s23, 10
    s_add_u32 s25, s25, s23
    s_add_u32 s25, s25, s17
    s_add_u32 s25, s25, 2097152
    s_lshr_b32 s37, s2, 3
    s_and_b32 s37, s37, 3
    s_lshl_b32 s37, s37, 3
    s_add_u32 s37, s37, s15
    s_branch R_JOIN
R_KGEN:
    s_mov_b32 s16, s22
    s_mov_b32 s18, s24
    s_mov_b32 s14, s20
    s_mul_i32 s25, s16, 27984
    s_lshl_b32 s23, s18, 8
    s_add_u32 s25, s25, s23
    s_add_u32 s25, s25, 86016
    v_lshlrev_b32 v15, 2, v0
    v_add_u32 v15, s25, v15
    s_cmp_eq_u32 s15, 0
    s_cbranch_scc1 KG_WP
    s_waitcnt vmcnt(5)
KG_WP:
    s_waitcnt vmcnt(6)
    s_waitcnt lgkmcnt(0)
    v_mov_b32 v66, 148084
    v_mov_b32 v67, 1
    s_mov_b64 exec, 1
    ds_add_u32 v66, v67
    s_mov_b64 exec, -1
    v_mov_b32 v66, 148084
    s_mov_b32 s43, 0
LW_7:
    ds_read_b32 v67, v66
    s_add_u32 s43, s43, 1
    s_waitcnt lgkmcnt(0)
    v_readfirstlane_b32 s42, v67
    s_cmp_gt_u32 s43, 0x80000
    s_cbranch_scc1 LW_7_x
    s_cmp_ge_u32 s42, 4
    s_cbranch_scc0 LW_7
LW_7_x:
    s_lshl_b32 s23, s16, 8
    v_lshlrev_b32 v9, 1, v0
    v_add_u32 v9, s23, v9
    s_lshl_b32 s23, s18, 7
    s_add_u32 s23, s23, 57344
    v_add_u32 v9, s23, v9
    ds_read_u16 v10, v9 offset:0
    ds_read_u16 v11, v9 offset:512
    ds_read_u16 v12, v9 offset:1024
    ds_read_u16 v13, v9 offset:1536
    s_waitcnt lgkmcnt(0)
    s_cmp_eq_u32 s16, 0
    s_cselect_b32 s23, 16, 0
    s_lshl_b32 s26, s26, s23
    s_and_b32 s26, s26, 0xffff0000
    s_lshl_b32 s27, s27, s23
    s_and_b32 s27, s27, 0xffff0000
    s_mov_b32 s23, 0x3fb8aa3b
    v_mov_b32 v20, s26
    v_lshlrev_b32 v10, 16, v10
    v_mul_f32 v20, s23, v20
    v_mul_f32 v10, s23, v10
    v_exp_f32 v20, v20
    v_exp_f32 v10, v10
    v_lshlrev_b32 v11, 16, v11
    v_cvt_pk_bf16_f32 v20, v20, v10
    v_lshlrev_b32 v12, 16, v12
    v_and_b32 v10, 0xffff0000, v20
    v_lshlrev_b32 v20, 16, v20
    v_lshlrev_b32 v13, 16, v13
    v_mul_f32 v10, v10, v20
    v_mul_f32 v11, v11, v20
    v_mul_f32 v16, 0xbfb8aa3b, v10
    v_mul_f32 v17, 0x3e22f983, v11
    v_add_f32 v20, v20, v20
    v_mul_f32 v18, v12, v20
    v_mul_f32_e64 v19, -v13, v20
    v_mul_f32 v48, 1.0, v16
    v_mul_f32 v50, 0x43800000, v16
    v_mul_f32 v49, 1.0, v17
    v_mul_f32 v51, 0x43800000, v17
    v_exp_f32 v48, v48
    v_exp_f32 v50, v50
    v_fract_f32 v49, v49
    v_fract_f32 v51, v51
    v_cos_f32 v24, v49
    v_cos_f32 v26, v51
    v_sin_f32 v25, v49
    v_sin_f32 v27, v51
    s_nop 0
    s_nop 0
    v_mul_f32 v24, v24, v48
    v_mul_f32 v26, v26, v50
    v_mul_f32_e64 v25, -v25, v48
    v_mul_f32_e64 v27, -v27, v50
    v_pk_mul_f32 v[34:35], v[24:25], v[24:25] op_sel:[0,0] op_sel_hi:[1,0]
    v_pk_mul_f32 v[36:37], v[26:27], v[26:27] op_sel:[0,0] op_sel_hi:[1,0]
    v_pk_mul_f32 v[38:39], v[18:19], v[24:25] op_sel:[0,0] op_sel_hi:[1,0]
    v_pk_mul_f32 v[40:41], v[18:19], v[26:27] op_sel:[0,0] op_sel_hi:[1,0]
    v_pk_fma_f32 v[28:29], v[24:25], v[24:25], v[34:35] op_sel:[1,1,0] op_sel_hi:[0,1,1] neg_lo:[0,1,0]
    v_pk_fma_f32 v[32:33], v[26:27], v[26:27], v[36:37] op_sel:[1,1,0] op_sel_hi:[0,1,1] neg_lo:[0,1,0]
    v_pk_fma_f32 v[60:61], v[18:19], v[24:25], v[38:39] op_sel:[1,1,0] op_sel_hi:[0,1,1] neg_lo:[0,1,0]
    v_pk_fma_f32 v[62:63], v[18:19], v[26:27], v[40:41] op_sel:[1,1,0] op_sel_hi:[0,1,1] neg_lo:[0,1,0]
    v_pk_mul_f32 v[34:35], v[28:29], v[28:29] op_sel:[0,0] op_sel_hi:[1,0]
    v_pk_mul_f32 v[36:37], v[18:19], v[28:29] op_sel:[0,0] op_sel_hi:[1,0]
    v_pk_mul_f32 v[38:39], v[60:61], v[28:29] op_sel:[0,0] op_sel_hi:[1,0]
    v_pk_mul_f32 v[40:41], v[62:63], v[28:29] op_sel:[0,0] op_sel_hi:[1,0]
    v_pk_mul_f32 v[42:43], v[62:63], v[26:27] op_sel:[0,0] op_sel_hi:[1,0]
    v_pk_mul_f32 v[44:45], v[62:63], v[32:33] op_sel:[0,0] op_sel_hi:[1,0]
    v_pk_fma_f32 v[30:31], v[28:29], v[28:29], v[34:35] op_sel:[1,1,0] op_sel_hi:[0,1,1] neg_lo:[0,1,0]
    v_pk_fma_f32 v[64:65], v[18:19], v[28:29], v[36:37] op_sel:[1,1,0] op_sel_hi:[0,1,1] neg_lo:[0,1,0]
    v_pk_fma_f32 v[66:67], v[60:61], v[28:29], v[38:39] op_sel:[1,1,0] op_sel_hi:[0,1,1] neg_lo:[0,1,0]
    v_pk_fma_f32 v[68:69], v[62:63], v[28:29], v[40:41] op_sel:[1,1,0] op_sel_hi:[0,1,1] neg_lo:[0,1,0]
    v_pk_fma_f32 v[70:71], v[62:63], v[26:27], v[42:43] op_sel:[1,1,0] op_sel_hi:[0,1,1] neg_lo:[0,1,0]
    v_pk_fma_f32 v[72:73], v[62:63], v[32:33], v[44:45] op_sel:[1,1,0] op_sel_hi:[0,1,1] neg_lo:[0,1,0]
    v_pk_mul_f32 v[34:35], v[18:19], v[30:31] op_sel:[0,0] op_sel_hi:[1,0]
    v_pk_mul_f32 v[36:37], v[60:61], v[30:31] op_sel:[0,0] op_sel_hi:[1,0]
    v_pk_mul_f32 v[38:39], v[64:65], v[30:31] op_sel:[0,0] op_sel_hi:[1,0]
    v_pk_mul_f32 v[40:41], v[66:67], v[30:31] op_sel:[0,0] op_sel_hi:[1,0]
    v_pk_mul_f32 v[42:43], v[68:69], v[28:29] op_sel:[0,0] op_sel_hi:[1,0]
    v_pk_mul_f32 v[44:45], v[70:71], v[32:33] op_sel:[0,0] op_sel_hi:[1,0]
    v_pk_mul_f32 v[46:47], v[72:73], v[32:33] op_sel:[0,0] op_sel_hi:[1,0]
    v_pk_fma_f32 v[74:75], v[18:19], v[30:31], v[34:35] op_sel:[1,1,0] op_sel_hi:[0,1,1] neg_lo:[0,1,0]
    v_pk_fma_f32 v[76:77], v[60:61], v[30:31], v[36:37] op_sel:[1,1,0] op_sel_hi:[0,1,1] neg_lo:[0,1,0]
    v_pk_fma_f32 v[78:79], v[64:65], v[30:31], v[38:39] op_sel:[1,1,0] op_sel_hi:[0,1,1] neg_lo:[0,1,0]
    v_pk_fma_f32 v[80:81], v[66:67], v[30:31], v[40:41] op_sel:[1,1,0] op_sel_hi:[0,1,1] neg_lo:[0,1,0]
    v_pk_fma_f32 v[82:83], v[68:69], v[28:29], v[42:43] op_sel:[1,1,0] op_sel_hi:[0,1,1] neg_lo:[0,1,0]
    v_pk_fma_f32 v[84:85], v[70:71], v[32:33], v[44:45] op_sel:[1,1,0] op_sel_hi:[0,1,1] neg_lo:[0,1,0]
    v_pk_fma_f32 v[86:87], v[72:73], v[32:33], v[46:47] op_sel:[1,1,0] op_sel_hi:[0,1,1] neg_lo:[0,1,0]
    v_pk_mul_f32 v[34:35], v[82:83], v[28:29] op_sel:[0,0] op_sel_hi:[1,0]
    v_pk_mul_f32 v[36:37], v[70:71], v[30:31] op_sel:[0,0] op_sel_hi:[1,0]
    v_pk_mul_f32 v[38:39], v[72:73], v[30:31] op_sel:[0,0] op_sel_hi:[1,0]
    v_pk_mul_f32 v[40:41], v[84:85], v[32:33] op_sel:[0,0] op_sel_hi:[1,0]
    v_pk_mul_f32 v[42:43], v[86:87], v[32:33] op_sel:[0,0] op_sel_hi:[1,0]
    v_pk_fma_f32 v[88:89], v[82:83], v[28:29], v[34:35] op_sel:[1,1,0] op_sel_hi:[0,1,1] neg_lo:[0,1,0]
    v_pk_fma_f32 v[90:91], v[70:71], v[30:31], v[36:37] op_sel:[1,1,0] op_sel_hi:[0,1,1] neg_lo:[0,1,0]
    v_pk_fma_f32 v[92:93], v[72:73], v[30:31], v[38:39] op_sel:[1,1,0] op_sel_hi:[0,1,1] neg_lo:[0,1,0]
    v_pk_fma_f32 v[94:95], v[84:85], v[32:33], v[40:41] op_sel:[1,1,0] op_sel_hi:[0,1,1] neg_lo:[0,1,0]
    v_pk_fma_f32 v[104:105], v[86:87], v[32:33], v[42:43] op_sel:[1,1,0] op_sel_hi:[0,1,1] neg_lo:[0,1,0]
    v_pk_mul_f32 v[34:35], v[94:95], v[32:33] op_sel:[0,0] op_sel_hi:[1,0]
    v_pk_fma_f32 v[106:107], v[94:95], v[32:33], v[34:35] op_sel:[1,1,0] op_sel_hi:[0,1,1] neg_lo:[0,1,0]
    v_cvt_pk_bf16_f32 v52, v18, v19
    v_cvt_pk_bf16_f32 v53, v60, v61
    ds_write_b32 v15, v52 offset:0
    v_cvt_pk_bf16_f32 v54, v64, v65
    ds_write_b32 v15, v53 offset:528
    v_cvt_pk_bf16_f32 v55, v66, v67
    ds_write_b32 v15, v54 offset:1056
    v_cvt_pk_bf16_f32 v56, v74, v75
    ds_write_b32 v15, v55 offset:1584
    v_cvt_pk_bf16_f32 v57, v76, v77
    ds_write_b32 v15, v56 offset:2112
    v_cvt_pk_bf16_f32 v58, v78, v79
    ds_write_b32 v15, v57 offset:2640
    v_cvt_pk_bf16_f32 v59, v80, v81
    ds_write_b32 v15, v58 offset:3168
    v_cvt_pk_bf16_f32 v52, v62, v63
    ds_write_b32 v15, v59 offset:3696
    v_cvt_pk_bf16_f32 v53, v68, v69
    ds_write_b32 v15, v52 offset:4224
    v_cvt_pk_bf16_f32 v54, v82, v83
    ds_write_b32 v15, v53 offset:4752
    v_cvt_pk_bf16_f32 v55, v88, v89
    ds_write_b32 v15, v54 offset:5280
    v_cvt_pk_bf16_f32 v56, v70, v71
    ds_write_b32 v15, v55 offset:5808
    v_cvt_pk_bf16_f32 v57, v90, v91
    ds_write_b32 v15, v56 offset:6336
    v_cvt_pk_bf16_f32 v58, v72, v73
    ds_write_b32 v15, v57 offset:6864
    v_cvt_pk_bf16_f32 v59, v92, v93
    ds_write_b32 v15, v58 offset:7392
    v_cvt_pk_bf16_f32 v52, v84, v85
    ds_write_b32 v15, v59 offset:7920
    v_cvt_pk_bf16_f32 v53, v86, v87
    ds_write_b32 v15, v52 offset:8448
    v_cvt_pk_bf16_f32 v54, v94, v95
    ds_write_b32 v15, v53 offset:8976
    v_cvt_pk_bf16_f32 v55, v104, v105
    ds_write_b32 v15, v54 offset:9504
    v_cvt_pk_bf16_f32 v56, v106, v107
    ds_write_b32 v15, v55 offset:10032
    ds_write_b32 v15, v56 offset:10560
    s_waitcnt lgkmcnt(0)
    v_mov_b32 v66, 147968
    v_mov_b32 v67, 1
    s_mov_b64 exec, 1
    ds_add_u32 v66, v67
    s_mov_b64 exec, -1
    s_waitcnt vmcnt(0)
    s_cmp_eq_u32 s15, 0
    s_cbranch_scc0 KG_NT
    v_readfirstlane_b32 s90, v127
    s_nop 3
    s_mul_i32 s90, s90, 0x9e3779b1
    s_add_u32 s90, s90, 0x7f4a7c15
    s_or_b32 s90, s90, 1
    v_mov_b32 v127, s90
    v_mov_b32 v126, 148064
    ds_write_b32 v126, v127
KG_NT:
    s_waitcnt lgkmcnt(0)
    v_mov_b32 v86, 148068
    v_mov_b32 v87, 1
    s_mov_b64 exec, 1
    ds_add_u32 v86, v87
    s_mov_b64 exec, -1
    v_and_b32 v9, 15, v0
    v_lshrrev_b32 v10, 4, v0
    v_mul_u32_u24 v11, 528, v9
    v_lshl_add_u32 v11, v10, 4, v11
    s_mul_i32 s25, s16, 27984
    s_add_u32 s25, s25, 86016
    s_mul_i32 s23, s18, 8448
    s_add_u32 s23, s23, s25
    v_add_u32 v12, s23, v11
    s_add_u32 s25, s25, 11088
    v_add_u32 v13, s25, v11
    s_lshl_b32 s25, s16, 11
    s_lshl_b32 s23, s18, 10
    s_add_u32 s25, s25, s23
    s_add_u32 s25, s25, 143360
    v_lshlrev_b32 v14, 8, v10
    v_lshl_add_u32 v14, v9, 1, v14
    v_add_u32 v14, s25, v14
    s_cmp_eq_u32 s18, 0
    s_cselect_b32 s27, s27, 0
    v_mov_b32 v15, s27
    v_mov_b32 v86, 147968
    s_mov_b32 s43, 0
LW_8:
    ds_read_b32 v87, v86
    s_add_u32 s43, s43, 1
    s_waitcnt lgkmcnt(0)
    v_readfirstlane_b32 s42, v87
    s_cmp_gt_u32 s43, 0x80000
    s_cbranch_scc1 LW_8_x
    s_cmp_ge_u32 s42, 8
    s_cbranch_scc0 LW_8
LW_8_x:
    ds_read_b128 v[16:19], v12 offset:0
    ds_read_b128 v[32:35], v13 offset:0
    ds_read_b128 v[48:51], v13 offset:8448
    ds_read_b128 v[20:23], v12 offset:64
    ds_read_b128 v[36:39], v13 offset:64
    ds_read_b128 v[52:55], v13 offset:8512
    ds_read_b128 v[24:27], v12 offset:128
    ds_read_b128 v[40:43], v13 offset:128
    ds_read_b128 v[56:59], v13 offset:8576
    ds_read_b128 v[28:31], v12 offset:192
    ds_read_b128 v[44:47], v13 offset:192
    ds_read_b128 v[60:63], v13 offset:8640
    s_waitcnt lgkmcnt(10)
    v_mfma_f32_16x16x32_bf16 v[120:123], v[16:19], v[32:35], 0
    s_waitcnt lgkmcnt(9)
    v_mfma_f32_16x16x32_bf16 v[4:7], v[16:19], v[48:51], 0
    ds_read_b128 v[16:19], v12 offset:256
    ds_read_b128 v[32:35], v13 offset:256
    ds_read_b128 v[48:51], v13 offset:8704
    s_waitcnt lgkmcnt(10)
    v_mfma_f32_16x16x32_bf16 v[120:123], v[20:23], v[36:39], v[120:123]
    s_waitcnt lgkmcnt(9)
    v_mfma_f32_16x16x32_bf16 v[4:7], v[20:23], v[52:55], v[4:7]
    ds_read_b128 v[20:23], v12 offset:320
    ds_read_b128 v[36:39], v13 offset:320
    ds_read_b128 v[52:55], v13 offset:8768
    s_waitcnt lgkmcnt(10)
    v_mfma_f32_16x16x32_bf16 v[120:123], v[24:27], v[40:43], v[120:123]
    s_waitcnt lgkmcnt(9)
    v_mfma_f32_16x16x32_bf16 v[4:7], v[24:27], v[56:59], v[4:7]
    ds_read_b128 v[24:27], v12 offset:384
    ds_read_b128 v[40:43], v13 offset:384
    ds_read_b128 v[56:59], v13 offset:8832
    s_waitcnt lgkmcnt(10)
    v_mfma_f32_16x16x32_bf16 v[120:123], v[28:31], v[44:47], v[120:123]
    s_waitcnt lgkmcnt(9)
    v_mfma_f32_16x16x32_bf16 v[4:7], v[28:31], v[60:63], v[4:7]
    ds_read_b128 v[28:31], v12 offset:448
    ds_read_b128 v[44:47], v13 offset:448
    ds_read_b128 v[60:63], v13 offset:8896
    s_waitcnt lgkmcnt(10)
    v_mfma_f32_16x16x32_bf16 v[120:123], v[16:19], v[32:35], v[120:123]
    s_waitcnt lgkmcnt(9)
    v_mfma_f32_16x16x32_bf16 v[4:7], v[16:19], v[48:51], v[4:7]
    s_waitcnt lgkmcnt(7)
    v_mfma_f32_16x16x32_bf16 v[120:123], v[20:23], v[36:39], v[120:123]
    s_waitcnt lgkmcnt(6)
    v_mfma_f32_16x16x32_bf16 v[4:7], v[20:23], v[52:55], v[4:7]
    s_waitcnt lgkmcnt(4)
    v_mfma_f32_16x16x32_bf16 v[120:123], v[24:27], v[40:43], v[120:123]
    s_waitcnt lgkmcnt(3)
    v_mfma_f32_16x16x32_bf16 v[4:7], v[24:27], v[56:59], v[4:7]
    s_waitcnt lgkmcnt(1)
    v_mfma_f32_16x16x32_bf16 v[120:123], v[28:31], v[44:47], v[120:123]
    s_waitcnt lgkmcnt(0)
    v_mfma_f32_16x16x32_bf16 v[4:7], v[28:31], v[60:63], v[4:7]
    s_nop 7
    v_cmp_eq_u32 vcc, 0, v0
    s_nop 1
    v_cndmask_b32 v15, 0, v15, vcc
    v_add_f32 v120, v120, v15
    v_cvt_pk_bf16_f32 v16, v120, v121
    v_cvt_pk_bf16_f32 v17, v122, v123
    ds_write_b16 v14, v16 offset:0
    ds_write_b16_d16_hi v14, v16 offset:64
    ds_write_b16 v14, v17 offset:128
    ds_write_b16_d16_hi v14, v17 offset:192
    v_cvt_pk_bf16_f32 v18, v4, v5
    v_cvt_pk_bf16_f32 v19, v6, v7
    ds_write_b16 v14, v18 offset:32
    ds_write_b16_d16_hi v14, v18 offset:96
    ds_write_b16 v14, v19 offset:160
    ds_write_b16_d16_hi v14, v19 offset:224
    s_waitcnt lgkmcnt(0)
    v_mov_b32 v2, 148088
    v_mov_b32 v3, 1
    s_mov_b64 exec, 1
    ds_add_u32 v2, v3
    s_mov_b64 exec, -1
    v_mov_b32 v2, 148088
    s_mov_b32 s43, 0
LW_9:
    ds_read_b32 v3, v2
    s_add_u32 s43, s43, 1
    s_waitcnt lgkmcnt(0)
    v_readfirstlane_b32 s42, v3
    s_cmp_gt_u32 s43, 0x80000
    s_cbranch_scc1 LW_9_x
    s_cmp_ge_u32 s42, 4
    s_cbranch_scc0 LW_9
LW_9_x:
    v_add_u32 v96, 143360, v96
    v_add_u32 v97, 143360, v97
    v_add_u32 v98, 143360, v98
    v_add_u32 v99, 143360, v99
    v_add_u32 v100, 143360, v100
    v_add_u32 v101, 143360, v101
    v_add_u32 v102, 143360, v102
    v_add_u32 v103, 143360, v103
    ds_read_u16 v16, v96 offset:0
    ds_read_u16_d16_hi v32, v97 offset:0
    ds_read_u16 v17, v98 offset:0
    ds_read_u16_d16_hi v33, v99 offset:0
    ds_read_u16 v18, v100 offset:0
    ds_read_u16_d16_hi v34, v101 offset:0
    ds_read_u16 v19, v102 offset:0
    ds_read_u16_d16_hi v35, v103 offset:0
    ds_read_u16 v20, v96 offset:2048
    ds_read_u16_d16_hi v36, v97 offset:2048
    ds_read_u16 v21, v98 offset:2048
    ds_read_u16_d16_hi v37, v99 offset:2048
    ds_read_u16 v22, v100 offset:2048
    ds_read_u16_d16_hi v38, v101 offset:2048
    ds_read_u16 v23, v102 offset:2048
    ds_read_u16_d16_hi v39, v103 offset:2048
    s_lshl_b32 s25, s15, 6
    v_add_u32 v9, s25, v0
    v_lshrrev_b32 v10, 2, v9
    v_mul_u32_u24 v10, 80, v10
    v_and_b32 v9, 3, v9
    v_lshl_add_u32 v10, v9, 4, v10
    v_add_u32 v10, 148480, v10
    v_mov_b32 v40, 0
    v_mov_b32 v41, 0
    v_mov_b32 v42, 0
    v_mov_b32 v43, 0
    s_mul_i32 s25, s16, 7680
    s_mul_i32 s23, s18, 1280
    s_add_u32 s25, s25, s23
    s_add_u32 s25, s25, 153600
    v_add_u32 v11, s25, v1
    ds_write_b128 v11, v[40:43]
    s_mov_b64 exec, 0xffff
    ds_write_b128 v11, v[40:43] offset:1024
    s_mov_b64 exec, -1
    s_waitcnt lgkmcnt(10)
    v_or_b32 v16, v16, v32
    v_or_b32 v17, v17, v33
    v_or_b32 v18, v18, v34
    v_or_b32 v19, v19, v35
    s_waitcnt lgkmcnt(2)
    v_or_b32 v20, v20, v36
    v_or_b32 v21, v21, v37
    v_or_b32 v22, v22, v38
    v_or_b32 v23, v23, v39
    ds_write_b128 v10, v[16:19]
    ds_write_b128 v10, v[20:23] offset:7680
    s_waitcnt lgkmcnt(0)
    s_barrier
    s_barrier
    s_barrier
    s_barrier
    v_mov_b32 v126, 148064
    s_mov_b32 s43, 0
GT_10:
    ds_read_b32 v127, v126
    s_add_u32 s43, s43, 1
    s_waitcnt lgkmcnt(0)
    v_readfirstlane_b32 s90, v127
    s_cmp_gt_u32 s43, 0x80000
    s_cbranch_scc1 GT_10_x
    s_cmp_eq_u32 s90, 0
    s_cbranch_scc1 GT_10
GT_10_x:
    s_and_b32 s14, s2, 7
    s_lshl_b32 s14, s14, 5
    s_lshr_b32 s17, s2, 3
    s_add_u32 s14, s14, s17
    s_lshl_b32 s14, s14, 1
    s_lshr_b32 s28, s14, 4
    s_lshl_b32 s28, s28, 13
    s_add_u32 s28, s28, 11862016
    v_lshlrev_b32 v104, 8, v0
    s_mov_b32 s40, 0
    s_barrier
    s_cmp_eq_u32 s15, 3
    s_cbranch_scc0 KG_L1
    s_mov_b32 s30, -1
    s_mov_b32 s31, 0
    s_mov_b64 exec, s[30:31]
    buffer_load_dword v105, v104, s[44:47], s28 offen sc1
    s_mov_b64 exec, -1
KG_L1:
    s_barrier
    s_cmp_eq_u32 s15, 3
    s_cbranch_scc0 KG_L2
    s_waitcnt vmcnt(0)
    s_mov_b32 s30, -1
    s_mov_b32 s31, 0
    v_cmp_ne_u32 vcc, s90, v105
    s_nop 1
    s_and_b64 vcc, vcc, s[30:31]
    s_cbranch_vccnz KG_L2
    v_mov_b32 v66, 148048
    v_mov_b32 v67, 1
    s_mov_b64 exec, 1
    ds_add_u32 v66, v67
    s_mov_b64 exec, -1
    s_mov_b32 s40, 1
KG_L2:
    s_barrier
    s_barrier
    s_cmp_eq_u32 s15, 3
    s_cbranch_scc0 KG_END2
    s_cmp_lg_u32 s40, 0
    s_cbranch_scc1 KG_END2
    s_mov_b32 s30, -1
    s_mov_b32 s31, 0
    s_mov_b64 exec, s[30:31]
    s_mov_b32 s29, 0
KG_PU:
    buffer_load_dword v105, v104, s[44:47], s28 offen sc1
    s_add_u32 s29, s29, 1
    s_waitcnt vmcnt(0)
    v_cmp_ne_u32 vcc, s90, v105
    s_cmp_gt_u32 s29, 0x10000
    s_cbranch_scc1 KG_PU_x
    s_cbranch_vccz KG_PU_x
    s_sleep 2
    s_branch KG_PU
KG_PU_x:
    s_mov_b64 exec, -1
    v_mov_b32 v66, 148048
    v_mov_b32 v67, 1
    s_mov_b64 exec, 1
    ds_add_u32 v66, v67
    s_mov_b64 exec, -1
KG_END2:
    s_branch R_LD
R_COMPUTE:
    v_and_b32 v4, 15, v0
    v_lshrrev_b32 v5, 4, v0
    v_lshrrev_b32 v6, 1, v4
    v_xor_b32 v6, v6, v5
    v_lshlrev_b32 v6, 4, v6
    v_lshl_add_u32 v6, v4, 7, v6
    s_lshr_b32 s17, s3, 1
    s_lshl_b32 s17, s17, 13
    v_add_u32 v112, s17, v6
    v_xor_b32 v113, 64, v112
    v_lshrrev_b32 v6, 2, v4
    v_lshl_add_u32 v6, v5, 3, v6
    v_mul_u32_u24 v6, 192, v6
    v_and_b32 v7, 3, v4
    v_lshl_add_u32 v6, v7, 3, v6
    s_and_b32 s17, s3, 1
    v_xor_b32 v7, s17, v5
    v_and_b32 v7, 1, v7
    v_lshl_add_u32 v118, v7, 5, v6
    s_and_b32 s18, s3, 1
    s_lshl_b32 s19, s13, 1
    s_add_u32 s18, s18, s19
    s_lshl_b32 s16, s18, 13
    s_lshl_b32 s18, s18, 16
    s_lshr_b32 s19, s3, 1
    s_lshl_b32 s24, s12, 1
    s_add_u32 s24, s24, s19
    s_lshl_b32 s25, s24, 8
    s_add_u32 s16, s16, s25
    s_add_u32 s16, s16, 11010048
    s_lshl_b32 s19, s24, 11
    s_add_u32 s18, s18, s19
    s_mov_b32 s17, 0x3eb8aa3b
    s_setprio 3
    s_and_b32 s20, s2, 7
    s_lshl_b32 s20, s20, 5
    s_lshr_b32 s21, s2, 3
    s_add_u32 s20, s20, s21
    s_lshl_b32 s20, s20, 1
    s_lshr_b32 s22, s3, 1
    s_and_b32 s24, s3, 1
    s_lshl_b32 s21, s20, 1
    s_add_u32 s28, s74, s21
    s_addc_u32 s29, s75, 0
    s_load_dword s26, s[28:29], 0
    s_mul_i32 s21, s22, 27984
    s_lshl_b32 s23, s24, 8
    s_add_u32 s21, s21, s23
    s_add_u32 s21, s21, 97104
    v_lshlrev_b32 v8, 2, v0
    v_add_u32 v8, s21, v8
    v_mov_b32 v22, 148084
    s_mov_b32 s43, 0
LW_11:
    ds_read_b32 v23, v22
    s_add_u32 s43, s43, 1
    s_waitcnt lgkmcnt(0)
    v_readfirstlane_b32 s42, v23
    s_cmp_gt_u32 s43, 0x80000
    s_cbranch_scc1 LW_11_x
    s_cmp_ge_u32 s42, 4
    s_cbranch_scc1 LW_11_x
    s_sleep 1
    s_branch LW_11
LW_11_x:
    s_lshl_b32 s21, s22, 8
    v_lshlrev_b32 v9, 1, v0
    v_add_u32 v9, s21, v9
    s_lshl_b32 s21, s24, 7
    s_add_u32 s21, s21, 57344
    v_add_u32 v9, s21, v9
    ds_read_u16 v10, v9 offset:0
    ds_read_u16 v11, v9 offset:512
    s_waitcnt lgkmcnt(0)
    s_cmp_eq_u32 s22, 0
    s_cselect_b32 s21, 16, 0
    s_lshl_b32 s26, s26, s21
    s_and_b32 s26, s26, 0xffff0000
    s_mov_b32 s21, 0x3fb8aa3b
    v_mov_b32 v20, s26
    v_lshlrev_b32 v10, 16, v10
    v_mul_f32 v20, s21, v20
    v_mul_f32 v10, s21, v10
    v_exp_f32 v20, v20
    v_exp_f32 v10, v10
    v_lshlrev_b32 v11, 16, v11
    v_cvt_pk_bf16_f32 v20, v20, v10
    v_and_b32 v10, 0xffff0000, v20
    v_lshlrev_b32 v20, 16, v20
    v_mul_f32 v10, v10, v20
    v_mul_f32 v11, v11, v20
    v_mul_f32 v16, 0xbfb8aa3b, v10
    v_mul_f32 v17, 0x3e22f983, v11
    v_mul_f32 v42, 0x41000000, v16
    v_mul_f32 v43, 0x41000000, v17
    v_exp_f32 v42, v42
    v_fract_f32 v43, v43
    v_cos_f32 v26, v43
    v_sin_f32 v27, v43
    s_nop 0
    v_mul_f32 v26, v26, v42
    v_mul_f32 v27, v27, v42
    v_mov_b32 v24, 1.0
    v_mov_b32 v25, 0
    v_pk_mul_f32 v[42:43], v[26:27], v[26:27] op_sel:[0,0] op_sel_hi:[1,0]
    v_pk_fma_f32 v[28:29], v[26:27], v[26:27], v[42:43] op_sel:[1,1,0] op_sel_hi:[0,1,1] neg_lo:[0,1,0]
    v_pk_mul_f32 v[42:43], v[26:27], v[28:29] op_sel:[0,0] op_sel_hi:[1,0]
    v_pk_mul_f32 v[44:45], v[28:29], v[28:29] op_sel:[0,0] op_sel_hi:[1,0]
    v_pk_fma_f32 v[30:31], v[26:27], v[28:29], v[42:43] op_sel:[1,1,0] op_sel_hi:[0,1,1] neg_lo:[0,1,0]
    v_pk_fma_f32 v[32:33], v[28:29], v[28:29], v[44:45] op_sel:[1,1,0] op_sel_hi:[0,1,1] neg_lo:[0,1,0]
    v_pk_mul_f32 v[42:43], v[32:33], v[26:27] op_sel:[0,0] op_sel_hi:[1,0]
    v_pk_mul_f32 v[44:45], v[32:33], v[28:29] op_sel:[0,0] op_sel_hi:[1,0]
    v_pk_mul_f32 v[46:47], v[32:33], v[30:31] op_sel:[0,0] op_sel_hi:[1,0]
    v_pk_mul_f32 v[48:49], v[32:33], v[32:33] op_sel:[0,0] op_sel_hi:[1,0]
    v_pk_fma_f32 v[34:35], v[32:33], v[26:27], v[42:43] op_sel:[1,1,0] op_sel_hi:[0,1,1] neg_lo:[0,1,0]
    v_pk_fma_f32 v[36:37], v[32:33], v[28:29], v[44:45] op_sel:[1,1,0] op_sel_hi:[0,1,1] neg_lo:[0,1,0]
    v_pk_fma_f32 v[38:39], v[32:33], v[30:31], v[46:47] op_sel:[1,1,0] op_sel_hi:[0,1,1] neg_lo:[0,1,0]
    v_pk_fma_f32 v[40:41], v[32:33], v[32:33], v[48:49] op_sel:[1,1,0] op_sel_hi:[0,1,1] neg_lo:[0,1,0]
    v_cvt_pk_bf16_f32 v58, v24, v25
    v_cvt_pk_bf16_f32 v59, v26, v27
    v_cvt_pk_bf16_f32 v60, v28, v29
    v_cvt_pk_bf16_f32 v61, v30, v31
    v_cvt_pk_bf16_f32 v62, v32, v33
    v_cvt_pk_bf16_f32 v63, v34, v35
    v_cvt_pk_bf16_f32 v64, v36, v37
    v_cvt_pk_bf16_f32 v65, v38, v39
    v_pk_mul_f32 v[42:43], v[24:25], v[40:41] op_sel:[0,0] op_sel_hi:[1,0]
    ds_write_b32 v8, v58 offset:0
    v_pk_mul_f32 v[44:45], v[26:27], v[40:41] op_sel:[0,0] op_sel_hi:[1,0]
    ds_write_b32 v8, v59 offset:528
    v_pk_mul_f32 v[46:47], v[28:29], v[40:41] op_sel:[0,0] op_sel_hi:[1,0]
    ds_write_b32 v8, v60 offset:1056
    v_pk_mul_f32 v[48:49], v[30:31], v[40:41] op_sel:[0,0] op_sel_hi:[1,0]
    ds_write_b32 v8, v61 offset:1584
    v_pk_mul_f32 v[50:51], v[32:33], v[40:41] op_sel:[0,0] op_sel_hi:[1,0]
    ds_write_b32 v8, v62 offset:2112
    v_pk_mul_f32 v[52:53], v[34:35], v[40:41] op_sel:[0,0] op_sel_hi:[1,0]
    ds_write_b32 v8, v63 offset:2640
    v_pk_mul_f32 v[54:55], v[36:37], v[40:41] op_sel:[0,0] op_sel_hi:[1,0]
    ds_write_b32 v8, v64 offset:3168
    v_pk_mul_f32 v[56:57], v[38:39], v[40:41] op_sel:[0,0] op_sel_hi:[1,0]
    ds_write_b32 v8, v65 offset:3696
    v_pk_fma_f32 v[24:25], v[24:25], v[40:41], v[42:43] op_sel:[1,1,0] op_sel_hi:[0,1,1] neg_lo:[0,1,0]
    v_pk_fma_f32 v[26:27], v[26:27], v[40:41], v[44:45] op_sel:[1,1,0] op_sel_hi:[0,1,1] neg_lo:[0,1,0]
    v_pk_fma_f32 v[28:29], v[28:29], v[40:41], v[46:47] op_sel:[1,1,0] op_sel_hi:[0,1,1] neg_lo:[0,1,0]
    v_pk_fma_f32 v[30:31], v[30:31], v[40:41], v[48:49] op_sel:[1,1,0] op_sel_hi:[0,1,1] neg_lo:[0,1,0]
    v_pk_fma_f32 v[32:33], v[32:33], v[40:41], v[50:51] op_sel:[1,1,0] op_sel_hi:[0,1,1] neg_lo:[0,1,0]
    v_pk_fma_f32 v[34:35], v[34:35], v[40:41], v[52:53] op_sel:[1,1,0] op_sel_hi:[0,1,1] neg_lo:[0,1,0]
    v_pk_fma_f32 v[36:37], v[36:37], v[40:41], v[54:55] op_sel:[1,1,0] op_sel_hi:[0,1,1] neg_lo:[0,1,0]
    v_pk_fma_f32 v[38:39], v[38:39], v[40:41], v[56:57] op_sel:[1,1,0] op_sel_hi:[0,1,1] neg_lo:[0,1,0]
    v_cvt_pk_bf16_f32 v58, v24, v25
    v_cvt_pk_bf16_f32 v59, v26, v27
    v_cvt_pk_bf16_f32 v60, v28, v29
    v_cvt_pk_bf16_f32 v61, v30, v31
    v_cvt_pk_bf16_f32 v62, v32, v33
    v_cvt_pk_bf16_f32 v63, v34, v35
    v_cvt_pk_bf16_f32 v64, v36, v37
    v_cvt_pk_bf16_f32 v65, v38, v39
    v_pk_mul_f32 v[42:43], v[24:25], v[40:41] op_sel:[0,0] op_sel_hi:[1,0]
    ds_write_b32 v8, v58 offset:4224
    v_pk_mul_f32 v[44:45], v[26:27], v[40:41] op_sel:[0,0] op_sel_hi:[1,0]
    ds_write_b32 v8, v59 offset:4752
    v_pk_mul_f32 v[46:47], v[28:29], v[40:41] op_sel:[0,0] op_sel_hi:[1,0]
    ds_write_b32 v8, v60 offset:5280
    v_pk_mul_f32 v[48:49], v[30:31], v[40:41] op_sel:[0,0] op_sel_hi:[1,0]
    ds_write_b32 v8, v61 offset:5808
    v_pk_mul_f32 v[50:51], v[32:33], v[40:41] op_sel:[0,0] op_sel_hi:[1,0]
    ds_write_b32 v8, v62 offset:6336
    v_pk_mul_f32 v[52:53], v[34:35], v[40:41] op_sel:[0,0] op_sel_hi:[1,0]
    ds_write_b32 v8, v63 offset:6864
    v_pk_mul_f32 v[54:55], v[36:37], v[40:41] op_sel:[0,0] op_sel_hi:[1,0]
    ds_write_b32 v8, v64 offset:7392
    v_pk_mul_f32 v[56:57], v[38:39], v[40:41] op_sel:[0,0] op_sel_hi:[1,0]
    ds_write_b32 v8, v65 offset:7920
    v_pk_fma_f32 v[24:25], v[24:25], v[40:41], v[42:43] op_sel:[1,1,0] op_sel_hi:[0,1,1] neg_lo:[0,1,0]
    v_pk_fma_f32 v[26:27], v[26:27], v[40:41], v[44:45] op_sel:[1,1,0] op_sel_hi:[0,1,1] neg_lo:[0,1,0]
    v_pk_fma_f32 v[28:29], v[28:29], v[40:41], v[46:47] op_sel:[1,1,0] op_sel_hi:[0,1,1] neg_lo:[0,1,0]
    v_pk_fma_f32 v[30:31], v[30:31], v[40:41], v[48:49] op_sel:[1,1,0] op_sel_hi:[0,1,1] neg_lo:[0,1,0]
    v_pk_fma_f32 v[32:33], v[32:33], v[40:41], v[50:51] op_sel:[1,1,0] op_sel_hi:[0,1,1] neg_lo:[0,1,0]
    v_pk_fma_f32 v[34:35], v[34:35], v[40:41], v[52:53] op_sel:[1,1,0] op_sel_hi:[0,1,1] neg_lo:[0,1,0]
    v_pk_fma_f32 v[36:37], v[36:37], v[40:41], v[54:55] op_sel:[1,1,0] op_sel_hi:[0,1,1] neg_lo:[0,1,0]
    v_pk_fma_f32 v[38:39], v[38:39], v[40:41], v[56:57] op_sel:[1,1,0] op_sel_hi:[0,1,1] neg_lo:[0,1,0]
    v_cvt_pk_bf16_f32 v58, v24, v25
    v_cvt_pk_bf16_f32 v59, v26, v27
    v_cvt_pk_bf16_f32 v60, v28, v29
    v_cvt_pk_bf16_f32 v61, v30, v31
    v_cvt_pk_bf16_f32 v62, v32, v33
    v_cvt_pk_bf16_f32 v63, v34, v35
    v_cvt_pk_bf16_f32 v64, v36, v37
    v_cvt_pk_bf16_f32 v65, v38, v39
    v_pk_mul_f32 v[42:43], v[24:25], v[40:41] op_sel:[0,0] op_sel_hi:[1,0]
    ds_write_b32 v8, v58 offset:8448
    v_pk_mul_f32 v[44:45], v[26:27], v[40:41] op_sel:[0,0] op_sel_hi:[1,0]
    ds_write_b32 v8, v59 offset:8976
    v_pk_mul_f32 v[46:47], v[28:29], v[40:41] op_sel:[0,0] op_sel_hi:[1,0]
    ds_write_b32 v8, v60 offset:9504
    v_pk_mul_f32 v[48:49], v[30:31], v[40:41] op_sel:[0,0] op_sel_hi:[1,0]
    ds_write_b32 v8, v61 offset:10032
    v_pk_mul_f32 v[50:51], v[32:33], v[40:41] op_sel:[0,0] op_sel_hi:[1,0]
    ds_write_b32 v8, v62 offset:10560
    v_pk_mul_f32 v[52:53], v[34:35], v[40:41] op_sel:[0,0] op_sel_hi:[1,0]
    ds_write_b32 v8, v63 offset:11088
    v_pk_mul_f32 v[54:55], v[36:37], v[40:41] op_sel:[0,0] op_sel_hi:[1,0]
    ds_write_b32 v8, v64 offset:11616
    v_pk_mul_f32 v[56:57], v[38:39], v[40:41] op_sel:[0,0] op_sel_hi:[1,0]
    ds_write_b32 v8, v65 offset:12144
    v_pk_fma_f32 v[24:25], v[24:25], v[40:41], v[42:43] op_sel:[1,1,0] op_sel_hi:[0,1,1] neg_lo:[0,1,0]
    v_pk_fma_f32 v[26:27], v[26:27], v[40:41], v[44:45] op_sel:[1,1,0] op_sel_hi:[0,1,1] neg_lo:[0,1,0]
    v_pk_fma_f32 v[28:29], v[28:29], v[40:41], v[46:47] op_sel:[1,1,0] op_sel_hi:[0,1,1] neg_lo:[0,1,0]
    v_pk_fma_f32 v[30:31], v[30:31], v[40:41], v[48:49] op_sel:[1,1,0] op_sel_hi:[0,1,1] neg_lo:[0,1,0]
    v_pk_fma_f32 v[32:33], v[32:33], v[40:41], v[50:51] op_sel:[1,1,0] op_sel_hi:[0,1,1] neg_lo:[0,1,0]
    v_pk_fma_f32 v[34:35], v[34:35], v[40:41], v[52:53] op_sel:[1,1,0] op_sel_hi:[0,1,1] neg_lo:[0,1,0]
    v_pk_fma_f32 v[36:37], v[36:37], v[40:41], v[54:55] op_sel:[1,1,0] op_sel_hi:[0,1,1] neg_lo:[0,1,0]
    v_pk_fma_f32 v[38:39], v[38:39], v[40:41], v[56:57] op_sel:[1,1,0] op_sel_hi:[0,1,1] neg_lo:[0,1,0]
    v_cvt_pk_bf16_f32 v58, v24, v25
    v_cvt_pk_bf16_f32 v59, v26, v27
    v_cvt_pk_bf16_f32 v60, v28, v29
    v_cvt_pk_bf16_f32 v61, v30, v31
    v_cvt_pk_bf16_f32 v62, v32, v33
    v_cvt_pk_bf16_f32 v63, v34, v35
    v_cvt_pk_bf16_f32 v64, v36, v37
    v_cvt_pk_bf16_f32 v65, v38, v39
    ds_write_b32 v8, v58 offset:12672
    ds_write_b32 v8, v59 offset:13200
    ds_write_b32 v8, v60 offset:13728
    ds_write_b32 v8, v61 offset:14256
    ds_write_b32 v8, v62 offset:14784
    ds_write_b32 v8, v63 offset:15312
    ds_write_b32 v8, v64 offset:15840
    ds_write_b32 v8, v65 offset:16368
    s_waitcnt lgkmcnt(0)
    v_mov_b32 v2, 147968
    v_mov_b32 v3, 1
    s_mov_b64 exec, 1
    ds_add_u32 v2, v3
    s_mov_b64 exec, -1
    v_and_b32 v80, 15, v0
    v_lshrrev_b32 v81, 4, v0
    v_lshrrev_b32 v82, 2, v80
    v_lshl_add_u32 v82, v81, 3, v82
    v_lshlrev_b32 v84, 5, v82
    v_lshlrev_b32 v82, 7, v82
    v_and_b32 v83, 3, v80
    v_lshl_add_u32 v82, v83, 3, v82
    v_lshl_add_u32 v84, v83, 3, v84
    v_add_u32 v84, 59392, v84
    s_lshl_b32 s20, s3, 5
    s_add_u32 s20, s20, 61440
    v_add_u32 v82, s20, v82
    v_lshlrev_b32 v83, 12, v80
    v_lshl_add_u32 v83, v81, 4, v83
    s_and_b32 s20, s2, 7
    s_lshl_b32 s20, s20, 2
    s_add_u32 s20, s20, s3
    s_lshl_b32 s21, s20, 13
    s_lshl_b32 s20, s20, 16
    s_lshr_b32 s22, s2, 3
    s_lshl_b32 s23, s22, 7
    s_add_u32 s20, s20, s23
    s_add_u32 s20, s20, 8388608
    s_lshl_b32 s23, s22, 8
    s_add_u32 s21, s21, s23
    s_add_u32 s21, s21, 11862016
    s_lshr_b32 s24, s2, 3
    s_lshl_b32 s22, s24, 11
    s_lshl_b32 s24, s24, 14
    s_and_b32 s19, s2, 7
    s_lshl_b32 s23, s19, 8
    s_lshl_b32 s19, s19, 11
    s_add_u32 s24, s24, s19
    s_add_u32 s24, s24, 10485760
    s_add_u32 s22, s22, s23
    s_add_u32 s22, s22, 11796480
    v_mov_b32 v86, 148068
    s_mov_b32 s43, 0
LW_12:
    ds_read_b32 v87, v86
    s_add_u32 s43, s43, 1
    s_waitcnt lgkmcnt(0)
    v_readfirstlane_b32 s42, v87
    s_cmp_gt_u32 s43, 0x80000
    s_cbranch_scc1 LW_12_x
    s_cmp_ge_u32 s42, 4
    s_cbranch_scc1 LW_12_x
    s_sleep 1
    s_branch LW_12
LW_12_x:
    ds_read_b64_tr_b16 v[64:65], v82 offset:0
    ds_read_b64_tr_b16 v[66:67], v82 offset:512
    ds_read_b64_tr_b16 v[68:69], v82 offset:4096
    ds_read_b64_tr_b16 v[70:71], v82 offset:4608
    ds_read_b64_tr_b16 v[72:73], v84 offset:0
    ds_read_b64_tr_b16 v[74:75], v84 offset:128
    ds_read_b64_tr_b16 v[76:77], v84 offset:1024
    ds_read_b64_tr_b16 v[78:79], v84 offset:1152
    s_waitcnt lgkmcnt(0)
    buffer_store_dwordx4 v[64:67], v83, s[44:47], s20 offen sc1
    buffer_store_dwordx4 v[68:71], v83, s[44:47], s20 offen offset:64 sc1
    s_cmp_eq_u32 s3, 0
    s_cbranch_scc0 PC_NW
    buffer_store_dwordx4 v[72:75], v1, s[44:47], s24 offen sc1
    buffer_store_dwordx4 v[76:79], v1, s[44:47], s24 offen offset:1024 sc1
PC_NW:
    v_mov_b32 v126, 148064
    s_mov_b32 s43, 0
GT_13:
    ds_read_b32 v127, v126
    s_add_u32 s43, s43, 1
    s_waitcnt lgkmcnt(0)
    v_readfirstlane_b32 s90, v127
    s_cmp_gt_u32 s43, 0x80000
    s_cbranch_scc1 GT_13_x
    s_cmp_eq_u32 s90, 0
    s_cbranch_scc1 GT_13
GT_13_x:
    s_mov_b32 s26, 0
    s_mov_b32 s27, 1
    v_add_u32 v114, s26, v112
    v_add_u32 v115, s26, v113
    v_add_u32 v116, s26, v118
    s_barrier
    ds_read_b64_tr_b16 v[24:25], v116 offset:16384
    ds_read_b64_tr_b16 v[26:27], v116 offset:17152
    ds_read_b128 v[8:11], v114 offset:0
    ds_read_b128 v[12:15], v114 offset:2048
    ds_read_b128 v[16:19], v114 offset:4096
    ds_read_b128 v[20:23], v114 offset:6144
    ds_read_b64_tr_b16 v[28:29], v116 offset:16448
    ds_read_b64_tr_b16 v[30:31], v116 offset:17216
    ds_read_b64_tr_b16 v[32:33], v116 offset:16512
    ds_read_b64_tr_b16 v[34:35], v116 offset:17280
    s_waitcnt lgkmcnt(7)
    v_mfma_f32_16x16x32_bf16 v[64:67], v[24:27], v[8:11], 0
    ds_read_b64_tr_b16 v[52:53], v116 offset:22528
    s_waitcnt lgkmcnt(7)
    v_mfma_f32_16x16x32_bf16 v[68:71], v[24:27], v[12:15], 0
    ds_read_b64_tr_b16 v[54:55], v116 offset:23296
    s_waitcnt lgkmcnt(7)
    v_mfma_f32_16x16x32_bf16 v[72:75], v[24:27], v[16:19], 0
    ds_read_b128 v[36:39], v115 offset:0
    s_waitcnt lgkmcnt(7)
    v_mfma_f32_16x16x32_bf16 v[76:79], v[24:27], v[20:23], 0
    ds_read_b128 v[40:43], v115 offset:2048
    s_waitcnt lgkmcnt(6)
    v_mfma_f32_16x16x32_bf16 v[80:83], v[28:31], v[8:11], 0
    ds_read_b128 v[44:47], v115 offset:4096
    v_mfma_f32_16x16x32_bf16 v[84:87], v[28:31], v[12:15], 0
    ds_read_b128 v[48:51], v115 offset:6144
    v_mfma_f32_16x16x32_bf16 v[88:91], v[28:31], v[16:19], 0
    ds_read_b64_tr_b16 v[56:57], v116 offset:22592
    v_mfma_f32_16x16x32_bf16 v[92:95], v[28:31], v[20:23], 0
    ds_read_b64_tr_b16 v[58:59], v116 offset:23360
    s_waitcnt lgkmcnt(8)
    v_mfma_f32_16x16x32_bf16 v[96:99], v[8:11], v[32:35], 0
    ds_read_b64_tr_b16 v[60:61], v116 offset:22656
    v_mfma_f32_16x16x32_bf16 v[100:103], v[12:15], v[32:35], 0
    ds_read_b64_tr_b16 v[62:63], v116 offset:23424
    v_mfma_f32_16x16x32_bf16 v[104:107], v[16:19], v[32:35], 0
    v_mfma_f32_16x16x32_bf16 v[108:111], v[20:23], v[32:35], 0
    s_waitcnt lgkmcnt(0)
PC_LOOP:
    s_add_u32 s26, s26, 28672
    s_cmp_eq_u32 s26, 86016
    s_cselect_b32 s26, 0, s26
    s_barrier
    v_add_u32 v114, s26, v112
    v_add_u32 v115, s26, v113
    v_add_u32 v116, s26, v118
    s_cmp_eq_u32 s27, 1
    s_cbranch_scc0 PC_NFL
    s_waitcnt vmcnt(0)
    v_mov_b32 v2, s90
    v_mov_b32 v3, 0
    s_mov_b64 exec, 1
    buffer_store_dword v2, v3, s[44:47], s21 offen sc1
    s_mov_b64 exec, -1
    s_cmp_eq_u32 s3, 0
    s_cbranch_scc0 PC_NFL
    v_mov_b32 v2, s90
    v_mov_b32 v3, 0
    s_mov_b64 exec, 1
    buffer_store_dword v2, v3, s[44:47], s22 offen sc1
    s_mov_b64 exec, -1
PC_NFL:
    v_mfma_f32_16x16x32_bf16 v[64:67], v[52:55], v[36:39], v[64:67]
    ds_read_b64_tr_b16 v[24:25], v116 offset:16384
    v_mfma_f32_16x16x32_bf16 v[68:71], v[52:55], v[40:43], v[68:71]
    ds_read_b64_tr_b16 v[26:27], v116 offset:17152
    v_mfma_f32_16x16x32_bf16 v[72:75], v[52:55], v[44:47], v[72:75]
    ds_read_b128 v[8:11], v114 offset:0
    v_mfma_f32_16x16x32_bf16 v[76:79], v[52:55], v[48:51], v[76:79]
    ds_read_b128 v[12:15], v114 offset:2048
    v_mfma_f32_16x16x32_bf16 v[80:83], v[56:59], v[36:39], v[80:83]
    ds_read_b128 v[16:19], v114 offset:4096
    v_mfma_f32_16x16x32_bf16 v[84:87], v[56:59], v[40:43], v[84:87]
    ds_read_b128 v[20:23], v114 offset:6144
    v_mfma_f32_16x16x32_bf16 v[88:91], v[56:59], v[44:47], v[88:91]
    ds_read_b64_tr_b16 v[28:29], v116 offset:16448
    v_mfma_f32_16x16x32_bf16 v[92:95], v[56:59], v[48:51], v[92:95]
    ds_read_b64_tr_b16 v[30:31], v116 offset:17216
    v_mfma_f32_16x16x32_bf16 v[96:99], v[36:39], v[60:63], v[96:99]
    ds_read_b64_tr_b16 v[32:33], v116 offset:16512
    v_mfma_f32_16x16x32_bf16 v[100:103], v[40:43], v[60:63], v[100:103]
    ds_read_b64_tr_b16 v[34:35], v116 offset:17280
    v_mfma_f32_16x16x32_bf16 v[104:107], v[44:47], v[60:63], v[104:107]
    v_mfma_f32_16x16x32_bf16 v[108:111], v[48:51], v[60:63], v[108:111]
    s_waitcnt lgkmcnt(7)
    v_mfma_f32_16x16x32_bf16 v[64:67], v[24:27], v[8:11], v[64:67]
    ds_read_b64_tr_b16 v[52:53], v116 offset:22528
    s_waitcnt lgkmcnt(7)
    v_mfma_f32_16x16x32_bf16 v[68:71], v[24:27], v[12:15], v[68:71]
    ds_read_b64_tr_b16 v[54:55], v116 offset:23296
    s_waitcnt lgkmcnt(7)
    v_mfma_f32_16x16x32_bf16 v[72:75], v[24:27], v[16:19], v[72:75]
    ds_read_b128 v[36:39], v115 offset:0
    s_waitcnt lgkmcnt(7)
    v_mfma_f32_16x16x32_bf16 v[76:79], v[24:27], v[20:23], v[76:79]
    ds_read_b128 v[40:43], v115 offset:2048
    s_waitcnt lgkmcnt(6)
    v_mfma_f32_16x16x32_bf16 v[80:83], v[28:31], v[8:11], v[80:83]
    ds_read_b128 v[44:47], v115 offset:4096
    v_mfma_f32_16x16x32_bf16 v[84:87], v[28:31], v[12:15], v[84:87]
    ds_read_b128 v[48:51], v115 offset:6144
    v_mfma_f32_16x16x32_bf16 v[88:91], v[28:31], v[16:19], v[88:91]
    ds_read_b64_tr_b16 v[56:57], v116 offset:22592
    v_mfma_f32_16x16x32_bf16 v[92:95], v[28:31], v[20:23], v[92:95]
    ds_read_b64_tr_b16 v[58:59], v116 offset:23360
    s_waitcnt lgkmcnt(8)
    v_mfma_f32_16x16x32_bf16 v[96:99], v[8:11], v[32:35], v[96:99]
    ds_read_b64_tr_b16 v[60:61], v116 offset:22656
    v_mfma_f32_16x16x32_bf16 v[100:103], v[12:15], v[32:35], v[100:103]
    ds_read_b64_tr_b16 v[62:63], v116 offset:23424
    v_mfma_f32_16x16x32_bf16 v[104:107], v[16:19], v[32:35], v[104:107]
    v_mfma_f32_16x16x32_bf16 v[108:111], v[20:23], v[32:35], v[108:111]
    s_waitcnt lgkmcnt(0)
    s_add_u32 s27, s27, 1
    s_cmp_lt_u32 s27, 8
    s_cbranch_scc1 PC_LOOP
    v_mov_b32 v4, 148044
    v_mov_b32 v5, 1
    s_mov_b64 exec, 1
    ds_add_u32 v4, v5
    s_mov_b64 exec, -1
    v_mfma_f32_16x16x32_bf16 v[64:67], v[52:55], v[36:39], v[64:67]
    v_mfma_f32_16x16x32_bf16 v[68:71], v[52:55], v[40:43], v[68:71]
    v_mfma_f32_16x16x32_bf16 v[72:75], v[52:55], v[44:47], v[72:75]
    v_mfma_f32_16x16x32_bf16 v[76:79], v[52:55], v[48:51], v[76:79]
    v_mfma_f32_16x16x32_bf16 v[80:83], v[56:59], v[36:39], v[80:83]
    v_mfma_f32_16x16x32_bf16 v[84:87], v[56:59], v[40:43], v[84:87]
    v_mfma_f32_16x16x32_bf16 v[88:91], v[56:59], v[44:47], v[88:91]
    v_mfma_f32_16x16x32_bf16 v[92:95], v[56:59], v[48:51], v[92:95]
    v_mfma_f32_16x16x32_bf16 v[96:99], v[36:39], v[60:63], v[96:99]
    v_mfma_f32_16x16x32_bf16 v[100:103], v[40:43], v[60:63], v[100:103]
    v_mfma_f32_16x16x32_bf16 v[104:107], v[44:47], v[60:63], v[104:107]
    v_mfma_f32_16x16x32_bf16 v[108:111], v[48:51], v[60:63], v[108:111]
    v_cvt_pk_bf16_f32 v8, v80, v81
    v_cvt_pk_bf16_f32 v9, v82, v83
    v_cvt_pk_bf16_f32 v10, v84, v85
    v_cvt_pk_bf16_f32 v11, v86, v87
    s_add_u32 s24, s18, 2097152
    s_nop 0
    v_permlane16_swap_b32 v8, v10
    v_permlane16_swap_b32 v9, v11
    s_nop 1
    buffer_store_dwordx4 v[8:11], v1, s[44:47], s24 offen sc1
    v_cvt_pk_bf16_f32 v12, v88, v89
    v_cvt_pk_bf16_f32 v13, v90, v91
    v_cvt_pk_bf16_f32 v14, v92, v93
    v_cvt_pk_bf16_f32 v15, v94, v95
    s_add_u32 s24, s18, 2098176
    s_nop 0
    v_permlane16_swap_b32 v12, v14
    v_permlane16_swap_b32 v13, v15
    s_nop 1
    buffer_store_dwordx4 v[12:15], v1, s[44:47], s24 offen sc1
    v_cvt_pk_bf16_f32 v16, v96, v97
    v_cvt_pk_bf16_f32 v17, v98, v99
    v_cvt_pk_bf16_f32 v18, v100, v101
    v_cvt_pk_bf16_f32 v19, v102, v103
    s_add_u32 s24, s18, 4194304
    s_nop 0
    v_permlane32_swap_b32 v16, v18
    v_permlane32_swap_b32 v17, v19
    s_nop 1
    buffer_store_dwordx4 v[16:19], v1, s[44:47], s24 offen sc1
    v_cvt_pk_bf16_f32 v20, v104, v105
    v_cvt_pk_bf16_f32 v21, v106, v107
    v_cvt_pk_bf16_f32 v22, v108, v109
    v_cvt_pk_bf16_f32 v23, v110, v111
    s_add_u32 s24, s18, 4195328
    s_nop 0
    v_permlane32_swap_b32 v20, v22
    v_permlane32_swap_b32 v21, v23
    s_nop 1
    buffer_store_dwordx4 v[20:23], v1, s[44:47], s24 offen sc1
    v_mul_f32 v64, s17, v64
    v_mul_f32 v65, s17, v65
    v_mul_f32 v66, s17, v66
    v_mul_f32 v67, s17, v67
    v_mul_f32 v68, s17, v68
    v_mul_f32 v69, s17, v69
    v_mul_f32 v70, s17, v70
    v_mul_f32 v71, s17, v71
    v_mul_f32 v72, s17, v72
    v_mul_f32 v73, s17, v73
    v_mul_f32 v74, s17, v74
    v_mul_f32 v75, s17, v75
    v_mul_f32 v76, s17, v76
    v_mul_f32 v77, s17, v77
    v_mul_f32 v78, s17, v78
    v_mul_f32 v79, s17, v79
    v_cvt_pk_bf16_f32 v24, v64, v65
    v_cvt_pk_bf16_f32 v25, v66, v67
    v_cvt_pk_bf16_f32 v26, v68, v69
    v_cvt_pk_bf16_f32 v27, v70, v71
    s_add_u32 s24, s18, 0
    s_nop 0
    v_permlane16_swap_b32 v24, v26
    v_permlane16_swap_b32 v25, v27
    s_nop 1
    buffer_store_dwordx4 v[24:27], v1, s[44:47], s24 offen sc1
    v_cvt_pk_bf16_f32 v28, v72, v73
    v_cvt_pk_bf16_f32 v29, v74, v75
    v_cvt_pk_bf16_f32 v30, v76, v77
    v_cvt_pk_bf16_f32 v31, v78, v79
    s_add_u32 s24, s18, 1024
    s_nop 0
    v_permlane16_swap_b32 v28, v30
    v_permlane16_swap_b32 v29, v31
    s_nop 1
    buffer_store_dwordx4 v[28:31], v1, s[44:47], s24 offen sc1
    s_waitcnt vmcnt(0)
    v_mov_b32 v126, 148064
    s_mov_b32 s43, 0
GT_14:
    ds_read_b32 v127, v126
    s_add_u32 s43, s43, 1
    s_waitcnt lgkmcnt(0)
    v_readfirstlane_b32 s90, v127
    s_cmp_gt_u32 s43, 0x80000
    s_cbranch_scc1 GT_14_x
    s_cmp_eq_u32 s90, 0
    s_cbranch_scc1 GT_14
GT_14_x:
    v_mov_b32 v2, s90
    v_mov_b32 v3, 0
    s_mov_b64 exec, 1
    buffer_store_dword v2, v3, s[44:47], s16 offen sc1
    s_mov_b64 exec, -1
    v_mov_b32 v2, 148076
    v_mov_b32 v3, 1
    s_mov_b64 exec, 1
    ds_add_u32 v2, v3
    s_mov_b64 exec, -1
    s_setprio 0
R_LD:
    s_and_b32 s12, s2, 7
    s_lshl_b32 s12, s12, 2
    s_lshr_b32 s13, s2, 3
    s_and_b32 s17, s13, 3
    s_add_u32 s12, s12, s17
    s_lshr_b32 s13, s2, 5
    s_lshl_b32 s17, s12, 16
    s_mov_b32 s20, 0x0000ffff
    s_mov_b32 s21, 0x0000ffff
    s_and_b32 s15, s3, 7
    s_lshr_b32 s16, s3, 3
    s_lshl_b32 s19, s16, 10
    v_add_u32 v2, s19, v1
    v_lshrrev_b32 v8, 5, v0
    v_lshlrev_b32 v8, 8, v8
    v_and_b32 v9, 15, v0
    v_lshlrev_b32 v9, 4, v9
    s_add_u32 s19, s19, 2048
    v_add3_u32 v3, v8, v9, s19
    v_and_b32 v8, 31, v0
    v_cmp_eq_u32 vcc, 16, v8
    v_mov_b32 v9, 0x3f803f80
    s_lshl_b32 s22, s15, 10
    s_add_u32 s22, s22, 49152
    v_cndmask_b32 v9, 0, v9, vcc
    v_add_u32 v4, s22, v1
    v_mov_b32 v16, v9
    v_mov_b32 v17, v9
    v_mov_b32 v18, v9
    v_mov_b32 v19, v9
    v_mov_b32 v20, v9
    v_mov_b32 v21, v9
    v_mov_b32 v22, v9
    v_mov_b32 v23, v9
    v_mov_b32 v24, v9
    v_mov_b32 v25, v9
    v_mov_b32 v26, v9
    v_mov_b32 v27, v9
    v_mov_b32 v28, v9
    v_mov_b32 v29, v9
    v_mov_b32 v30, v9
    v_mov_b32 v31, v9
    v_mov_b32 v88, 0
    s_lshl_b32 s18, s13, 3
    s_add_u32 s18, s18, s15
    s_lshl_b32 s19, s18, 13
    s_lshl_b32 s22, s12, 8
    s_add_u32 s19, s19, s22
    s_add_u32 s19, s19, 11272192
    s_lshl_b32 s18, s18, 10
    s_add_u32 s18, s18, s17
    s_lshr_b32 s22, s3, 2
    s_and_b32 s23, s3, 3
    s_lshl_b32 s24, s23, 12
    s_lshl_b32 s26, s22, 10
    s_add_u32 s24, s24, s26
    v_add_u32 v124, s24, v1
    s_and_b32 s25, s22, 1
    s_lshl_b32 s25, s25, 15
    s_lshr_b32 s26, s22, 1
    s_lshl_b32 s26, s26, 21
    s_add_u32 s25, s25, s26
    s_lshl_b32 s23, s23, 10
    s_add_u32 s25, s25, s23
    s_add_u32 s25, s25, s17
    s_add_u32 s25, s25, 2097152
    s_lshr_b32 s37, s2, 3
    s_and_b32 s37, s37, 3
    s_lshl_b32 s37, s37, 3
    s_add_u32 s37, s37, s15
    s_cmp_lt_u32 s3, 4
    s_cselect_b32 s28, 0, 8
    s_sub_u32 s28, s3, s28
    v_lshlrev_b32 v8, 8, v0
    s_lshl_b32 s27, s12, 13
    s_add_u32 s27, s27, 11010048
    s_lshr_b32 s22, s28, 1
    s_and_b32 s23, s28, 1
    s_lshl_b32 s23, s23, 1
    s_and_b32 s4, s22, 1
    s_lshl_b32 s4, s4, 15
    s_lshr_b32 s26, s22, 1
    s_lshl_b32 s26, s26, 21
    s_add_u32 s4, s4, s26
    s_lshl_b32 s26, s23, 10
    s_add_u32 s4, s4, s26
    s_add_u32 s4, s4, s17
    s_add_u32 s4, s4, 2097152
    s_lshl_b32 s24, s23, 12
    s_lshl_b32 s26, s22, 10
    s_add_u32 s24, s24, s26
    v_add_u32 v89, s24, v1
    s_lshl_b32 s5, s13, 3
    s_add_u32 s5, s5, s28
    s_lshl_b32 s5, s5, 10
    s_add_u32 s5, s5, s17
    s_lshl_b32 s6, s28, 10
    s_add_u32 s6, s6, 49152
    v_add_u32 v12, s6, v1
    s_cmp_eq_u32 s3, 13
    s_cbranch_scc0 LD_NOPOLL
    v_mov_b32 v44, 148076
    s_mov_b32 s43, 0
LW_15:
    ds_read_b32 v45, v44
    s_add_u32 s43, s43, 1
    s_waitcnt lgkmcnt(0)
    v_readfirstlane_b32 s42, v45
    s_cmp_gt_u32 s43, 0x80000
    s_cbranch_scc1 LW_15_x
    s_cmp_ge_u32 s42, 4
    s_cbranch_scc1 LW_15_x
    s_sleep 2
    s_branch LW_15
LW_15_x:
    s_mov_b32 s30, -1
    s_mov_b32 s31, 0
    s_mov_b64 exec, s[30:31]
    s_mov_b32 s29, 0
LD_POLL:
    buffer_load_dword v13, v8, s[44:47], s27 offen sc1
    s_add_u32 s29, s29, 1
    s_waitcnt vmcnt(0)
    v_cmp_ne_u32 vcc, s90, v13
    s_cmp_gt_u32 s29, 0x10000
    s_cbranch_scc1 LD_POLL_x
    s_cbranch_vccz LD_POLL_x
    s_sleep 2
    s_branch LD_POLL
LD_POLL_x:
    s_mov_b64 exec, -1
    v_mov_b32 v44, 148052
    v_mov_b32 v45, 1
    s_mov_b64 exec, 1
    ds_add_u32 v44, v45
    s_mov_b64 exec, -1
LD_NOPOLL:
    v_mov_b32 v44, 148052
    s_mov_b32 s43, 0
LW_16:
    ds_read_b32 v45, v44
    s_add_u32 s43, s43, 1
    s_waitcnt lgkmcnt(0)
    v_readfirstlane_b32 s42, v45
    s_cmp_gt_u32 s43, 0x80000
    s_cbranch_scc1 LW_16_x
    s_cmp_ge_u32 s42, 1
    s_cbranch_scc1 LW_16_x
    s_sleep 1
    s_branch LW_16
LW_16_x:
    s_add_u32 s26, s13, 0
    s_and_b32 s26, s26, 7
    s_lshl_b32 s26, s26, 12
    s_add_u32 s26, s26, s4
    buffer_load_dwordx4 v[32:35], v1, s[44:47], s26 offen sc1
    buffer_load_dwordx4 v[36:39], v1, s[44:47], s26 offen offset:1024 sc1
    buffer_load_dwordx4 v[40:43], v1, s[44:47], s5 offen sc1
    s_add_u32 s26, s13, 1
    s_and_b32 s26, s26, 7
    s_lshl_b32 s26, s26, 12
    s_add_u32 s26, s26, s4
    buffer_load_dwordx4 v[92:95], v1, s[44:47], s26 offen sc1
    buffer_load_dwordx4 v[96:99], v1, s[44:47], s26 offen offset:1024 sc1
    s_add_u32 s26, s13, 2
    s_and_b32 s26, s26, 7
    s_lshl_b32 s26, s26, 12
    s_add_u32 s26, s26, s4
    buffer_load_dwordx4 v[100:103], v1, s[44:47], s26 offen sc1
    buffer_load_dwordx4 v[104:107], v1, s[44:47], s26 offen offset:1024 sc1
    v_mov_b32 v44, 148044
    s_mov_b32 s43, 0
LW_17:
    ds_read_b32 v45, v44
    s_add_u32 s43, s43, 1
    s_waitcnt lgkmcnt(0)
    v_readfirstlane_b32 s42, v45
    s_cmp_gt_u32 s43, 0x80000
    s_cbranch_scc1 LW_17_x
    s_cmp_ge_u32 s42, 4
    s_cbranch_scc0 LW_17
LW_17_x:
    s_waitcnt vmcnt(4)
    ds_write_b128 v89, v[32:35]
    ds_write_b128 v89, v[36:39] offset:4096
    ds_write_b128 v12, v[40:43]
    s_waitcnt vmcnt(2)
    ds_write_b128 v89, v[92:95] offset:16384
    ds_write_b128 v89, v[96:99] offset:20480
    s_waitcnt vmcnt(0)
    ds_write_b128 v89, v[100:103] offset:32768
    ds_write_b128 v89, v[104:107] offset:36864
R_JOIN:
    s_setprio 3
    s_waitcnt lgkmcnt(0)
    s_barrier
    ds_read_b128 v[4:7], v4
    ds_read_b128 v[8:11], v2 offset:0
    ds_read_b128 v[12:15], v2 offset:4096
    s_mov_b64 exec, s[20:21]
    ds_read_b128 v[16:19], v3 offset:0
    ds_read_b128 v[20:23], v3 offset:512
    s_mov_b64 exec, -1
    s_waitcnt lgkmcnt(3)
    v_mfma_f32_32x32x16_bf16 v[32:47], v[8:11], v[4:7], 0
    s_nop 7
    s_nop 3
    s_setprio 3
    v_exp_f32 v32, v32
    v_exp_f32 v33, v33
    s_mov_b64 exec, s[20:21]
    ds_read_b128 v[24:27], v3 offset:4096
    ds_read_b128 v[28:31], v3 offset:4608
    s_mov_b64 exec, -1
    v_exp_f32 v34, v34
    v_exp_f32 v35, v35
    v_cvt_pk_bf16_f32 v64, v32, v33
    v_exp_f32 v36, v36
    v_exp_f32 v37, v37
    v_cvt_pk_bf16_f32 v65, v34, v35
    s_waitcnt lgkmcnt(4)
    v_mfma_f32_32x32x16_bf16 v[48:63], v[12:15], v[4:7], 0
    s_add_u32 s26, s13, 3
    s_and_b32 s26, s26, 7
    s_lshl_b32 s26, s26, 12
    s_add_u32 s26, s26, s25
    buffer_load_dwordx4 v[108:111], v1, s[44:47], s26 offen sc1
    ds_read_b128 v[8:11], v2 offset:8192
    v_exp_f32 v38, v38
    v_exp_f32 v39, v39
    v_cvt_pk_bf16_f32 v66, v36, v37
    v_exp_f32 v40, v40
    v_exp_f32 v41, v41
    v_cvt_pk_bf16_f32 v67, v38, v39
    v_exp_f32 v42, v42
    v_exp_f32 v43, v43
    s_waitcnt lgkmcnt(3)
    v_mfma_f32_32x32x16_bf16 v[72:87], v[16:19], v[64:67], 0
    v_cvt_pk_bf16_f32 v68, v40, v41
    v_exp_f32 v44, v44
    v_exp_f32 v45, v45
    v_cvt_pk_bf16_f32 v69, v42, v43
    v_exp_f32 v46, v46
    v_exp_f32 v47, v47
    v_cvt_pk_bf16_f32 v70, v44, v45
    v_cvt_pk_bf16_f32 v71, v46, v47
    v_exp_f32 v48, v48
    v_exp_f32 v49, v49
    v_mfma_f32_32x32x16_bf16 v[72:87], v[20:23], v[68:71], v[72:87]
    s_mov_b64 exec, s[20:21]
    ds_read_b128 v[16:19], v3 offset:8192
    ds_read_b128 v[20:23], v3 offset:8704
    s_mov_b64 exec, -1
    v_exp_f32 v50, v50
    v_exp_f32 v51, v51
    v_cvt_pk_bf16_f32 v64, v48, v49
    v_exp_f32 v52, v52
    v_exp_f32 v53, v53
    v_cvt_pk_bf16_f32 v65, v50, v51
    s_waitcnt lgkmcnt(2)
    v_mfma_f32_32x32x16_bf16 v[32:47], v[8:11], v[4:7], 0
    s_cmp_eq_u32 s16, 0
    s_cbranch_scc0 AT_NS
    v_mov_b32 v96, -1
    v_mov_b32 v97, -1
    v_mov_b32 v98, -1
    v_mov_b32 v99, -1
    s_add_u32 s26, s18, 6291456
    buffer_store_dwordx4 v[96:99], v1, s[44:47], s26 offen sc1
AT_NS:
    s_add_u32 s26, s13, 4
    s_and_b32 s26, s26, 7
    s_lshl_b32 s26, s26, 12
    s_add_u32 s26, s26, s25
    buffer_load_dwordx4 v[112:115], v1, s[44:47], s26 offen sc1
    ds_read_b128 v[12:15], v2 offset:12288
    v_exp_f32 v54, v54
    v_exp_f32 v55, v55
    v_cvt_pk_bf16_f32 v66, v52, v53
    v_exp_f32 v56, v56
    v_exp_f32 v57, v57
    v_cvt_pk_bf16_f32 v67, v54, v55
    v_exp_f32 v58, v58
    v_exp_f32 v59, v59
    v_mfma_f32_32x32x16_bf16 v[72:87], v[24:27], v[64:67], v[72:87]
    v_cvt_pk_bf16_f32 v68, v56, v57
    v_exp_f32 v60, v60
    v_exp_f32 v61, v61
    v_cvt_pk_bf16_f32 v69, v58, v59
    v_exp_f32 v62, v62
    v_exp_f32 v63, v63
    v_cvt_pk_bf16_f32 v70, v60, v61
    v_cvt_pk_bf16_f32 v71, v62, v63
    v_exp_f32 v32, v32
    v_exp_f32 v33, v33
    v_mfma_f32_32x32x16_bf16 v[72:87], v[28:31], v[68:71], v[72:87]
    s_mov_b64 exec, s[20:21]
    ds_read_b128 v[24:27], v3 offset:12288
    ds_read_b128 v[28:31], v3 offset:12800
    s_mov_b64 exec, -1
    v_exp_f32 v34, v34
    v_exp_f32 v35, v35
    v_cvt_pk_bf16_f32 v64, v32, v33
    v_exp_f32 v36, v36
    v_exp_f32 v37, v37
    v_cvt_pk_bf16_f32 v65, v34, v35
    s_waitcnt lgkmcnt(2)
    v_mfma_f32_32x32x16_bf16 v[48:63], v[12:15], v[4:7], 0
    s_add_u32 s26, s13, 5
    s_and_b32 s26, s26, 7
    s_lshl_b32 s26, s26, 12
    s_add_u32 s26, s26, s25
    buffer_load_dwordx4 v[116:119], v1, s[44:47], s26 offen sc1
    ds_read_b128 v[8:11], v2 offset:16384
    v_exp_f32 v38, v38
    v_exp_f32 v39, v39
    v_cvt_pk_bf16_f32 v66, v36, v37
    v_exp_f32 v40, v40
    v_exp_f32 v41, v41
    v_cvt_pk_bf16_f32 v67, v38, v39
    v_exp_f32 v42, v42
    v_exp_f32 v43, v43
    v_mfma_f32_32x32x16_bf16 v[72:87], v[16:19], v[64:67], v[72:87]
    v_cvt_pk_bf16_f32 v68, v40, v41
    v_exp_f32 v44, v44
    v_exp_f32 v45, v45
    v_cvt_pk_bf16_f32 v69, v42, v43
    v_exp_f32 v46, v46
    v_exp_f32 v47, v47
    v_cvt_pk_bf16_f32 v70, v44, v45
    v_cvt_pk_bf16_f32 v71, v46, v47
    v_exp_f32 v48, v48
    v_exp_f32 v49, v49
    v_mfma_f32_32x32x16_bf16 v[72:87], v[20:23], v[68:71], v[72:87]
    s_mov_b64 exec, s[20:21]
    ds_read_b128 v[16:19], v3 offset:16384
    ds_read_b128 v[20:23], v3 offset:16896
    s_mov_b64 exec, -1
    v_exp_f32 v50, v50
    v_exp_f32 v51, v51
    v_cvt_pk_bf16_f32 v64, v48, v49
    v_exp_f32 v52, v52
    v_exp_f32 v53, v53
    v_cvt_pk_bf16_f32 v65, v50, v51
    s_waitcnt lgkmcnt(2)
    v_mfma_f32_32x32x16_bf16 v[32:47], v[8:11], v[4:7], 0
    s_add_u32 s26, s13, 6
    s_and_b32 s26, s26, 7
    s_lshl_b32 s26, s26, 12
    s_add_u32 s26, s26, s25
    buffer_load_dwordx4 v[120:123], v1, s[44:47], s26 offen sc1
    ds_read_b128 v[12:15], v2 offset:20480
    v_exp_f32 v54, v54
    v_exp_f32 v55, v55
    v_cvt_pk_bf16_f32 v66, v52, v53
    v_exp_f32 v56, v56
    v_exp_f32 v57, v57
    v_cvt_pk_bf16_f32 v67, v54, v55
    v_exp_f32 v58, v58
    v_exp_f32 v59, v59
    v_mfma_f32_32x32x16_bf16 v[72:87], v[24:27], v[64:67], v[72:87]
    v_cvt_pk_bf16_f32 v68, v56, v57
    v_exp_f32 v60, v60
    v_exp_f32 v61, v61
    v_cvt_pk_bf16_f32 v69, v58, v59
    v_exp_f32 v62, v62
    v_exp_f32 v63, v63
    v_cvt_pk_bf16_f32 v70, v60, v61
    v_cvt_pk_bf16_f32 v71, v62, v63
    v_exp_f32 v32, v32
    v_exp_f32 v33, v33
    v_mfma_f32_32x32x16_bf16 v[72:87], v[28:31], v[68:71], v[72:87]
    s_mov_b64 exec, s[20:21]
    ds_read_b128 v[24:27], v3 offset:20480
    ds_read_b128 v[28:31], v3 offset:20992
    s_mov_b64 exec, -1
    v_exp_f32 v34, v34
    v_exp_f32 v35, v35
    v_cvt_pk_bf16_f32 v64, v32, v33
    v_exp_f32 v36, v36
    v_exp_f32 v37, v37
    v_cvt_pk_bf16_f32 v65, v34, v35
    s_waitcnt lgkmcnt(2)
    v_mfma_f32_32x32x16_bf16 v[48:63], v[12:15], v[4:7], 0
    s_add_u32 s26, s13, 7
    s_and_b32 s26, s26, 7
    s_lshl_b32 s26, s26, 12
    s_add_u32 s26, s26, s25
    buffer_load_dwordx4 v[92:95], v1, s[44:47], s26 offen sc1
    ds_read_b128 v[8:11], v2 offset:24576
    v_exp_f32 v38, v38
    v_exp_f32 v39, v39
    v_cvt_pk_bf16_f32 v66, v36, v37
    v_exp_f32 v40, v40
    v_exp_f32 v41, v41
    v_cvt_pk_bf16_f32 v67, v38, v39
    v_exp_f32 v42, v42
    v_exp_f32 v43, v43
    v_mfma_f32_32x32x16_bf16 v[72:87], v[16:19], v[64:67], v[72:87]
    v_cvt_pk_bf16_f32 v68, v40, v41
    v_exp_f32 v44, v44
    v_exp_f32 v45, v45
    v_cvt_pk_bf16_f32 v69, v42, v43
    v_exp_f32 v46, v46
    v_exp_f32 v47, v47
    v_cvt_pk_bf16_f32 v70, v44, v45
    v_cvt_pk_bf16_f32 v71, v46, v47
    v_exp_f32 v48, v48
    v_exp_f32 v49, v49
    v_mfma_f32_32x32x16_bf16 v[72:87], v[20:23], v[68:71], v[72:87]
    s_mov_b64 exec, s[20:21]
    ds_read_b128 v[16:19], v3 offset:24576
    ds_read_b128 v[20:23], v3 offset:25088
    s_mov_b64 exec, -1
    v_exp_f32 v50, v50
    v_exp_f32 v51, v51
    v_cvt_pk_bf16_f32 v64, v48, v49
    v_exp_f32 v52, v52
    v_exp_f32 v53, v53
    v_cvt_pk_bf16_f32 v65, v50, v51
    s_waitcnt lgkmcnt(2)
    v_mfma_f32_32x32x16_bf16 v[32:47], v[8:11], v[4:7], 0
    ds_read_b128 v[12:15], v2 offset:28672
    v_exp_f32 v54, v54
    v_exp_f32 v55, v55
    v_cvt_pk_bf16_f32 v66, v52, v53
    v_exp_f32 v56, v56
    v_exp_f32 v57, v57
    v_cvt_pk_bf16_f32 v67, v54, v55
    v_exp_f32 v58, v58
    v_exp_f32 v59, v59
    v_mfma_f32_32x32x16_bf16 v[72:87], v[24:27], v[64:67], v[72:87]
    v_cvt_pk_bf16_f32 v68, v56, v57
    v_exp_f32 v60, v60
    v_exp_f32 v61, v61
    v_cvt_pk_bf16_f32 v69, v58, v59
    v_exp_f32 v62, v62
    v_exp_f32 v63, v63
    v_cvt_pk_bf16_f32 v70, v60, v61
    v_cvt_pk_bf16_f32 v71, v62, v63
    v_exp_f32 v32, v32
    v_exp_f32 v33, v33
    v_mfma_f32_32x32x16_bf16 v[72:87], v[28:31], v[68:71], v[72:87]
    s_mov_b64 exec, s[20:21]
    ds_read_b128 v[24:27], v3 offset:28672
    ds_read_b128 v[28:31], v3 offset:29184
    s_mov_b64 exec, -1
    v_exp_f32 v34, v34
    v_exp_f32 v35, v35
    v_cvt_pk_bf16_f32 v64, v32, v33
    v_exp_f32 v36, v36
    v_exp_f32 v37, v37
    v_cvt_pk_bf16_f32 v65, v34, v35
    s_waitcnt lgkmcnt(2)
    v_mfma_f32_32x32x16_bf16 v[48:63], v[12:15], v[4:7], 0
    s_waitcnt vmcnt(0)
    ds_write_b128 v124, v[108:111] offset:49152
    v_add_u32 v124, 65536, v124
    ds_write_b128 v124, v[112:115] offset:0
    ds_write_b128 v124, v[116:119] offset:16384
    ds_write_b128 v124, v[120:123] offset:32768
    ds_write_b128 v124, v[92:95] offset:49152
    s_waitcnt lgkmcnt(0)
    v_mov_b32 v89, 148096
    v_mov_b32 v124, 1
    s_mov_b64 exec, 1
    ds_add_u32 v89, v124
    s_mov_b64 exec, -1
    ds_read_b128 v[8:11], v2 offset:32768
    v_exp_f32 v38, v38
    v_exp_f32 v39, v39
    v_cvt_pk_bf16_f32 v66, v36, v37
    v_exp_f32 v40, v40
    v_exp_f32 v41, v41
    v_cvt_pk_bf16_f32 v67, v38, v39
    v_exp_f32 v42, v42
    v_exp_f32 v43, v43
    v_mfma_f32_32x32x16_bf16 v[72:87], v[16:19], v[64:67], v[72:87]
    v_cvt_pk_bf16_f32 v68, v40, v41
    v_exp_f32 v44, v44
    v_exp_f32 v45, v45
    v_cvt_pk_bf16_f32 v69, v42, v43
    v_exp_f32 v46, v46
    v_exp_f32 v47, v47
    v_cvt_pk_bf16_f32 v70, v44, v45
    v_cvt_pk_bf16_f32 v71, v46, v47
    v_exp_f32 v48, v48
    v_exp_f32 v49, v49
    v_mfma_f32_32x32x16_bf16 v[72:87], v[20:23], v[68:71], v[72:87]
    s_mov_b64 exec, s[20:21]
    ds_read_b128 v[16:19], v3 offset:32768
    ds_read_b128 v[20:23], v3 offset:33280
    s_mov_b64 exec, -1
    v_exp_f32 v50, v50
    v_exp_f32 v51, v51
    v_cvt_pk_bf16_f32 v64, v48, v49
    v_exp_f32 v52, v52
    v_exp_f32 v53, v53
    v_cvt_pk_bf16_f32 v65, v50, v51
    s_waitcnt lgkmcnt(2)
    v_mfma_f32_32x32x16_bf16 v[32:47], v[8:11], v[4:7], 0
    ds_read_b128 v[12:15], v2 offset:36864
    v_exp_f32 v54, v54
    v_exp_f32 v55, v55
    v_cvt_pk_bf16_f32 v66, v52, v53
    v_exp_f32 v56, v56
    v_exp_f32 v57, v57
    v_cvt_pk_bf16_f32 v67, v54, v55
    v_exp_f32 v58, v58
    v_exp_f32 v59, v59
    v_mfma_f32_32x32x16_bf16 v[72:87], v[24:27], v[64:67], v[72:87]
    v_cvt_pk_bf16_f32 v68, v56, v57
    v_exp_f32 v60, v60
    v_exp_f32 v61, v61
    v_cvt_pk_bf16_f32 v69, v58, v59
    v_exp_f32 v62, v62
    v_exp_f32 v63, v63
    v_cvt_pk_bf16_f32 v70, v60, v61
    v_cvt_pk_bf16_f32 v71, v62, v63
    s_setprio 2
    v_exp_f32 v32, v32
    v_exp_f32 v33, v33
    v_mfma_f32_32x32x16_bf16 v[72:87], v[28:31], v[68:71], v[72:87]
    s_mov_b64 exec, s[20:21]
    ds_read_b128 v[24:27], v3 offset:36864
    ds_read_b128 v[28:31], v3 offset:37376
    s_mov_b64 exec, -1
    v_exp_f32 v34, v34
    v_exp_f32 v35, v35
    v_cvt_pk_bf16_f32 v64, v32, v33
    v_exp_f32 v36, v36
    v_exp_f32 v37, v37
    v_cvt_pk_bf16_f32 v65, v34, v35
    s_waitcnt lgkmcnt(2)
    v_mfma_f32_32x32x16_bf16 v[48:63], v[12:15], v[4:7], 0
    ds_read_b128 v[8:11], v2 offset:40960
    v_exp_f32 v38, v38
    v_exp_f32 v39, v39
    v_cvt_pk_bf16_f32 v66, v36, v37
    v_exp_f32 v40, v40
    v_exp_f32 v41, v41
    v_cvt_pk_bf16_f32 v67, v38, v39
    v_exp_f32 v42, v42
    v_exp_f32 v43, v43
    v_mfma_f32_32x32x16_bf16 v[72:87], v[16:19], v[64:67], v[72:87]
    v_cvt_pk_bf16_f32 v68, v40, v41
    v_exp_f32 v44, v44
    v_exp_f32 v45, v45
    v_cvt_pk_bf16_f32 v69, v42, v43
    v_exp_f32 v46, v46
    v_exp_f32 v47, v47
    v_cvt_pk_bf16_f32 v70, v44, v45
    v_cvt_pk_bf16_f32 v71, v46, v47
    v_exp_f32 v48, v48
    v_exp_f32 v49, v49
    v_mfma_f32_32x32x16_bf16 v[72:87], v[20:23], v[68:71], v[72:87]
    s_mov_b64 exec, s[20:21]
    ds_read_b128 v[16:19], v3 offset:40960
    ds_read_b128 v[20:23], v3 offset:41472
    s_mov_b64 exec, -1
    v_exp_f32 v50, v50
    v_exp_f32 v51, v51
    v_cvt_pk_bf16_f32 v64, v48, v49
    v_exp_f32 v52, v52
    v_exp_f32 v53, v53
    v_cvt_pk_bf16_f32 v65, v50, v51
    s_waitcnt lgkmcnt(2)
    v_mfma_f32_32x32x16_bf16 v[32:47], v[8:11], v[4:7], 0
    ds_read_b32 v124, v89
    ds_read_b128 v[12:15], v2 offset:45056
    v_exp_f32 v54, v54
    v_exp_f32 v55, v55
    v_cvt_pk_bf16_f32 v66, v52, v53
    v_exp_f32 v56, v56
    v_exp_f32 v57, v57
    v_cvt_pk_bf16_f32 v67, v54, v55
    v_exp_f32 v58, v58
    v_exp_f32 v59, v59
    v_mfma_f32_32x32x16_bf16 v[72:87], v[24:27], v[64:67], v[72:87]
    v_cvt_pk_bf16_f32 v68, v56, v57
    v_exp_f32 v60, v60
    v_exp_f32 v61, v61
    v_cvt_pk_bf16_f32 v69, v58, v59
    v_exp_f32 v62, v62
    v_exp_f32 v63, v63
    v_cvt_pk_bf16_f32 v70, v60, v61
    v_cvt_pk_bf16_f32 v71, v62, v63
    v_exp_f32 v32, v32
    v_exp_f32 v33, v33
    v_mfma_f32_32x32x16_bf16 v[72:87], v[28:31], v[68:71], v[72:87]
    s_mov_b64 exec, s[20:21]
    ds_read_b128 v[24:27], v3 offset:45056
    ds_read_b128 v[28:31], v3 offset:45568
    s_mov_b64 exec, -1
    v_exp_f32 v34, v34
    v_exp_f32 v35, v35
    v_cvt_pk_bf16_f32 v64, v32, v33
    v_exp_f32 v36, v36
    v_exp_f32 v37, v37
    v_cvt_pk_bf16_f32 v65, v34, v35
    s_waitcnt lgkmcnt(2)
    v_mfma_f32_32x32x16_bf16 v[48:63], v[12:15], v[4:7], 0
    v_readfirstlane_b32 s42, v124
    s_nop 0
    s_cmp_ge_u32 s42, 16
    s_cbranch_scc1 AT_LANDED
AT_LSPIN:
    ds_read_b32 v124, v89
    s_waitcnt lgkmcnt(0)
    v_readfirstlane_b32 s42, v124
    s_sleep 1
    s_cmp_ge_u32 s42, 16
    s_cbranch_scc0 AT_LSPIN
AT_LANDED:
    v_lshlrev_b32 v89, 8, v0
    s_lshl_b32 s26, s37, 11
    s_add_u32 s26, s26, 11796480
    s_mov_b64 exec, 0xff
    buffer_load_dword v124, v89, s[44:47], s26 offen sc1
    s_mov_b64 exec, -1
    ds_read_b128 v[8:11], v2 offset:49152
    v_exp_f32 v38, v38
    v_exp_f32 v39, v39
    v_cvt_pk_bf16_f32 v66, v36, v37
    v_exp_f32 v40, v40
    v_exp_f32 v41, v41
    v_cvt_pk_bf16_f32 v67, v38, v39
    v_exp_f32 v42, v42
    v_exp_f32 v43, v43
    v_mfma_f32_32x32x16_bf16 v[72:87], v[16:19], v[64:67], v[72:87]
    v_cvt_pk_bf16_f32 v68, v40, v41
    v_exp_f32 v44, v44
    v_exp_f32 v45, v45
    v_cvt_pk_bf16_f32 v69, v42, v43
    v_exp_f32 v46, v46
    v_exp_f32 v47, v47
    v_cvt_pk_bf16_f32 v70, v44, v45
    v_cvt_pk_bf16_f32 v71, v46, v47
    v_exp_f32 v48, v48
    v_exp_f32 v49, v49
    v_mfma_f32_32x32x16_bf16 v[72:87], v[20:23], v[68:71], v[72:87]
    s_mov_b64 exec, s[20:21]
    ds_read_b128 v[16:19], v3 offset:49152
    ds_read_b128 v[20:23], v3 offset:49664
    s_mov_b64 exec, -1
    v_exp_f32 v50, v50
    v_exp_f32 v51, v51
    v_cvt_pk_bf16_f32 v64, v48, v49
    v_exp_f32 v52, v52
    v_exp_f32 v53, v53
    v_cvt_pk_bf16_f32 v65, v50, v51
    s_waitcnt lgkmcnt(2)
    v_mfma_f32_32x32x16_bf16 v[32:47], v[8:11], v[4:7], 0
    s_cmp_eq_u32 s3, 9
    s_cbranch_scc0 AT_NF4
    s_lshl_b32 s29, s13, 13
    s_lshl_b32 s28, s12, 8
    s_add_u32 s28, s29, s28
    s_add_u32 s28, s28, 12189696
    v_mov_b32 v120, s90
    v_mov_b32 v121, 0
    s_mov_b64 exec, 1
    buffer_store_dword v120, v121, s[44:47], s28 offen sc1
    s_mov_b64 exec, -1
AT_NF4:
    ds_read_b128 v[12:15], v2 offset:53248
    v_exp_f32 v54, v54
    v_exp_f32 v55, v55
    v_cvt_pk_bf16_f32 v66, v52, v53
    v_exp_f32 v56, v56
    v_exp_f32 v57, v57
    v_cvt_pk_bf16_f32 v67, v54, v55
    v_exp_f32 v58, v58
    v_exp_f32 v59, v59
    v_mfma_f32_32x32x16_bf16 v[72:87], v[24:27], v[64:67], v[72:87]
    v_cvt_pk_bf16_f32 v68, v56, v57
    v_exp_f32 v60, v60
    v_exp_f32 v61, v61
    v_cvt_pk_bf16_f32 v69, v58, v59
    v_exp_f32 v62, v62
    v_exp_f32 v63, v63
    v_cvt_pk_bf16_f32 v70, v60, v61
    v_cvt_pk_bf16_f32 v71, v62, v63
    v_exp_f32 v32, v32
    v_exp_f32 v33, v33
    v_mfma_f32_32x32x16_bf16 v[72:87], v[28:31], v[68:71], v[72:87]
    s_mov_b64 exec, s[20:21]
    ds_read_b128 v[24:27], v3 offset:53248
    ds_read_b128 v[28:31], v3 offset:53760
    s_mov_b64 exec, -1
    v_exp_f32 v34, v34
    v_exp_f32 v35, v35
    v_cvt_pk_bf16_f32 v64, v32, v33
    v_exp_f32 v36, v36
    v_exp_f32 v37, v37
    v_cvt_pk_bf16_f32 v65, v34, v35
    s_waitcnt lgkmcnt(2)
    v_mfma_f32_32x32x16_bf16 v[48:63], v[12:15], v[4:7], 0
    s_waitcnt vmcnt(0)
    s_mov_b32 s30, 0xff
    s_mov_b32 s31, 0
    v_cmp_ne_u32 vcc, s90, v124
    s_nop 1
    s_and_b64 vcc, vcc, s[30:31]
    s_cbranch_vccz AT_P3_ok
    s_mov_b32 s30, 0xff
    s_mov_b32 s31, 0
    s_mov_b64 exec, s[30:31]
    s_mov_b32 s29, 0
AT_P3:
    buffer_load_dword v124, v89, s[44:47], s26 offen sc1
    s_add_u32 s29, s29, 1
    s_waitcnt vmcnt(0)
    v_cmp_ne_u32 vcc, s90, v124
    s_cmp_gt_u32 s29, 0x10000
    s_cbranch_scc1 AT_P3_x
    s_cbranch_vccz AT_P3_x
    s_sleep 4
    s_branch AT_P3
AT_P3_x:
    s_mov_b64 exec, -1
AT_P3_ok:
    s_lshl_b32 s27, s37, 14
    s_lshl_b32 s26, s16, 13
    s_add_u32 s27, s27, s26
    s_add_u32 s27, s27, 10485760
    buffer_load_dwordx4 v[92:95], v1, s[44:47], s27 offen sc1
    s_add_u32 s27, s27, 1024
    ds_read_b128 v[8:11], v2 offset:57344
    v_exp_f32 v38, v38
    v_exp_f32 v39, v39
    v_cvt_pk_bf16_f32 v66, v36, v37
    v_exp_f32 v40, v40
    v_exp_f32 v41, v41
    v_cvt_pk_bf16_f32 v67, v38, v39
    v_exp_f32 v42, v42
    v_exp_f32 v43, v43
    v_mfma_f32_32x32x16_bf16 v[72:87], v[16:19], v[64:67], v[72:87]
    v_cvt_pk_bf16_f32 v68, v40, v41
    v_exp_f32 v44, v44
    v_exp_f32 v45, v45
    v_cvt_pk_bf16_f32 v69, v42, v43
    v_exp_f32 v46, v46
    v_exp_f32 v47, v47
    v_cvt_pk_bf16_f32 v70, v44, v45
    v_cvt_pk_bf16_f32 v71, v46, v47
    v_exp_f32 v48, v48
    v_exp_f32 v49, v49
    v_mfma_f32_32x32x16_bf16 v[72:87], v[20:23], v[68:71], v[72:87]
    s_mov_b64 exec, s[20:21]
    ds_read_b128 v[16:19], v3 offset:57344
    ds_read_b128 v[20:23], v3 offset:57856
    s_mov_b64 exec, -1
    v_exp_f32 v50, v50
    v_exp_f32 v51, v51
    v_cvt_pk_bf16_f32 v64, v48, v49
    v_exp_f32 v52, v52
    v_exp_f32 v53, v53
    v_cvt_pk_bf16_f32 v65, v50, v51
    s_waitcnt lgkmcnt(2)
    v_mfma_f32_32x32x16_bf16 v[32:47], v[8:11], v[4:7], 0
    buffer_load_dwordx4 v[96:99], v1, s[44:47], s27 offen sc1
    s_add_u32 s27, s27, 1024
    ds_read_b128 v[12:15], v2 offset:61440
    v_exp_f32 v54, v54
    v_exp_f32 v55, v55
    v_cvt_pk_bf16_f32 v66, v52, v53
    v_exp_f32 v56, v56
    v_exp_f32 v57, v57
    v_cvt_pk_bf16_f32 v67, v54, v55
    v_exp_f32 v58, v58
    v_exp_f32 v59, v59
    v_mfma_f32_32x32x16_bf16 v[72:87], v[24:27], v[64:67], v[72:87]
    v_cvt_pk_bf16_f32 v68, v56, v57
    v_exp_f32 v60, v60
    v_exp_f32 v61, v61
    v_cvt_pk_bf16_f32 v69, v58, v59
    v_exp_f32 v62, v62
    v_exp_f32 v63, v63
    v_cvt_pk_bf16_f32 v70, v60, v61
    v_cvt_pk_bf16_f32 v71, v62, v63
    v_exp_f32 v32, v32
    v_exp_f32 v33, v33
    v_mfma_f32_32x32x16_bf16 v[72:87], v[28:31], v[68:71], v[72:87]
    s_mov_b64 exec, s[20:21]
    ds_read_b128 v[24:27], v3 offset:61440
    ds_read_b128 v[28:31], v3 offset:61952
    s_mov_b64 exec, -1
    v_exp_f32 v34, v34
    v_exp_f32 v35, v35
    v_cvt_pk_bf16_f32 v64, v32, v33
    v_exp_f32 v36, v36
    v_exp_f32 v37, v37
    v_cvt_pk_bf16_f32 v65, v34, v35
    s_waitcnt lgkmcnt(2)
    v_mfma_f32_32x32x16_bf16 v[48:63], v[12:15], v[4:7], 0
    buffer_load_dwordx4 v[100:103], v1, s[44:47], s27 offen sc1
    s_add_u32 s27, s27, 1024
    v_add_u32 v2, 65536, v2
    ds_read_b128 v[8:11], v2 offset:0
    v_exp_f32 v38, v38
    v_exp_f32 v39, v39
    v_cvt_pk_bf16_f32 v66, v36, v37
    v_exp_f32 v40, v40
    v_exp_f32 v41, v41
    v_cvt_pk_bf16_f32 v67, v38, v39
    v_exp_f32 v42, v42
    v_exp_f32 v43, v43
    v_mfma_f32_32x32x16_bf16 v[72:87], v[16:19], v[64:67], v[72:87]
    v_cvt_pk_bf16_f32 v68, v40, v41
    v_exp_f32 v44, v44
    v_exp_f32 v45, v45
    v_cvt_pk_bf16_f32 v69, v42, v43
    v_exp_f32 v46, v46
    v_exp_f32 v47, v47
    v_cvt_pk_bf16_f32 v70, v44, v45
    v_cvt_pk_bf16_f32 v71, v46, v47
    v_exp_f32 v48, v48
    v_exp_f32 v49, v49
    v_mfma_f32_32x32x16_bf16 v[72:87], v[20:23], v[68:71], v[72:87]
    v_add_u32 v3, 65536, v3
    s_mov_b64 exec, s[20:21]
    ds_read_b128 v[16:19], v3 offset:0
    ds_read_b128 v[20:23], v3 offset:512
    s_mov_b64 exec, -1
    v_exp_f32 v50, v50
    v_exp_f32 v51, v51
    v_cvt_pk_bf16_f32 v64, v48, v49
    v_exp_f32 v52, v52
    v_exp_f32 v53, v53
    v_cvt_pk_bf16_f32 v65, v50, v51
    s_waitcnt lgkmcnt(2)
    v_mfma_f32_32x32x16_bf16 v[32:47], v[8:11], v[4:7], 0
    buffer_load_dwordx4 v[104:107], v1, s[44:47], s27 offen sc1
    s_add_u32 s27, s27, 1024
    ds_read_b128 v[12:15], v2 offset:4096
    v_exp_f32 v54, v54
    v_exp_f32 v55, v55
    v_cvt_pk_bf16_f32 v66, v52, v53
    v_exp_f32 v56, v56
    v_exp_f32 v57, v57
    v_cvt_pk_bf16_f32 v67, v54, v55
    v_exp_f32 v58, v58
    v_exp_f32 v59, v59
    v_mfma_f32_32x32x16_bf16 v[72:87], v[24:27], v[64:67], v[72:87]
    v_cvt_pk_bf16_f32 v68, v56, v57
    v_exp_f32 v60, v60
    v_exp_f32 v61, v61
    v_cvt_pk_bf16_f32 v69, v58, v59
    v_exp_f32 v62, v62
    v_exp_f32 v63, v63
    v_cvt_pk_bf16_f32 v70, v60, v61
    v_cvt_pk_bf16_f32 v71, v62, v63
    s_setprio 1
    v_exp_f32 v32, v32
    v_exp_f32 v33, v33
    v_mfma_f32_32x32x16_bf16 v[72:87], v[28:31], v[68:71], v[72:87]
    s_mov_b64 exec, s[20:21]
    ds_read_b128 v[24:27], v3 offset:4096
    ds_read_b128 v[28:31], v3 offset:4608
    s_mov_b64 exec, -1
    v_exp_f32 v34, v34
    v_exp_f32 v35, v35
    v_cvt_pk_bf16_f32 v64, v32, v33
    v_exp_f32 v36, v36
    v_exp_f32 v37, v37
    v_cvt_pk_bf16_f32 v65, v34, v35
    s_waitcnt lgkmcnt(2)
    v_mfma_f32_32x32x16_bf16 v[48:63], v[12:15], v[4:7], 0
    buffer_load_dwordx4 v[108:111], v1, s[44:47], s27 offen sc1
    s_add_u32 s27, s27, 1024
    ds_read_b128 v[8:11], v2 offset:8192
    v_exp_f32 v38, v38
    v_exp_f32 v39, v39
    v_cvt_pk_bf16_f32 v66, v36, v37
    v_exp_f32 v40, v40
    v_exp_f32 v41, v41
    v_cvt_pk_bf16_f32 v67, v38, v39
    v_exp_f32 v42, v42
    v_exp_f32 v43, v43
    v_mfma_f32_32x32x16_bf16 v[72:87], v[16:19], v[64:67], v[72:87]
    v_cvt_pk_bf16_f32 v68, v40, v41
    v_exp_f32 v44, v44
    v_exp_f32 v45, v45
    v_cvt_pk_bf16_f32 v69, v42, v43
    v_exp_f32 v46, v46
    v_exp_f32 v47, v47
    v_cvt_pk_bf16_f32 v70, v44, v45
    v_cvt_pk_bf16_f32 v71, v46, v47
    v_exp_f32 v48, v48
    v_exp_f32 v49, v49
    v_mfma_f32_32x32x16_bf16 v[72:87], v[20:23], v[68:71], v[72:87]
    s_mov_b64 exec, s[20:21]
    ds_read_b128 v[16:19], v3 offset:8192
    ds_read_b128 v[20:23], v3 offset:8704
    s_mov_b64 exec, -1
    v_exp_f32 v50, v50
    v_exp_f32 v51, v51
    v_cvt_pk_bf16_f32 v64, v48, v49
    v_exp_f32 v52, v52
    v_exp_f32 v53, v53
    v_cvt_pk_bf16_f32 v65, v50, v51
    s_waitcnt lgkmcnt(2)
    v_mfma_f32_32x32x16_bf16 v[32:47], v[8:11], v[4:7], 0
    buffer_load_dwordx4 v[112:115], v1, s[44:47], s27 offen sc1
    s_add_u32 s27, s27, 1024
    ds_read_b128 v[12:15], v2 offset:12288
    v_exp_f32 v54, v54
    v_exp_f32 v55, v55
    v_cvt_pk_bf16_f32 v66, v52, v53
    v_exp_f32 v56, v56
    v_exp_f32 v57, v57
    v_cvt_pk_bf16_f32 v67, v54, v55
    v_exp_f32 v58, v58
    v_exp_f32 v59, v59
    v_mfma_f32_32x32x16_bf16 v[72:87], v[24:27], v[64:67], v[72:87]
    v_cvt_pk_bf16_f32 v68, v56, v57
    v_exp_f32 v60, v60
    v_exp_f32 v61, v61
    v_cvt_pk_bf16_f32 v69, v58, v59
    v_exp_f32 v62, v62
    v_exp_f32 v63, v63
    v_cvt_pk_bf16_f32 v70, v60, v61
    v_cvt_pk_bf16_f32 v71, v62, v63
    v_exp_f32 v32, v32
    v_exp_f32 v33, v33
    v_mfma_f32_32x32x16_bf16 v[72:87], v[28:31], v[68:71], v[72:87]
    s_mov_b64 exec, s[20:21]
    ds_read_b128 v[24:27], v3 offset:12288
    ds_read_b128 v[28:31], v3 offset:12800
    s_mov_b64 exec, -1
    v_exp_f32 v34, v34
    v_exp_f32 v35, v35
    v_cvt_pk_bf16_f32 v64, v32, v33
    v_exp_f32 v36, v36
    v_exp_f32 v37, v37
    v_cvt_pk_bf16_f32 v65, v34, v35
    s_waitcnt lgkmcnt(2)
    v_mfma_f32_32x32x16_bf16 v[48:63], v[12:15], v[4:7], 0
    buffer_load_dwordx4 v[116:119], v1, s[44:47], s27 offen sc1
    s_add_u32 s27, s27, 1024
    ds_read_b128 v[8:11], v2 offset:16384
    v_exp_f32 v38, v38
    v_exp_f32 v39, v39
    v_cvt_pk_bf16_f32 v66, v36, v37
    v_exp_f32 v40, v40
    v_exp_f32 v41, v41
    v_cvt_pk_bf16_f32 v67, v38, v39
    v_exp_f32 v42, v42
    v_exp_f32 v43, v43
    v_mfma_f32_32x32x16_bf16 v[72:87], v[16:19], v[64:67], v[72:87]
    v_cvt_pk_bf16_f32 v68, v40, v41
    v_exp_f32 v44, v44
    v_exp_f32 v45, v45
    v_cvt_pk_bf16_f32 v69, v42, v43
    v_exp_f32 v46, v46
    v_exp_f32 v47, v47
    v_cvt_pk_bf16_f32 v70, v44, v45
    v_cvt_pk_bf16_f32 v71, v46, v47
    v_exp_f32 v48, v48
    v_exp_f32 v49, v49
    v_mfma_f32_32x32x16_bf16 v[72:87], v[20:23], v[68:71], v[72:87]
    s_mov_b64 exec, s[20:21]
    ds_read_b128 v[16:19], v3 offset:16384
    ds_read_b128 v[20:23], v3 offset:16896
    s_mov_b64 exec, -1
    v_exp_f32 v50, v50
    v_exp_f32 v51, v51
    v_cvt_pk_bf16_f32 v64, v48, v49
    v_exp_f32 v52, v52
    v_exp_f32 v53, v53
    v_cvt_pk_bf16_f32 v65, v50, v51
    s_waitcnt lgkmcnt(2)
    v_mfma_f32_32x32x16_bf16 v[32:47], v[8:11], v[4:7], 0
    buffer_load_dwordx4 v[120:123], v1, s[44:47], s27 offen sc1
    s_add_u32 s27, s27, 1024
    ds_read_b128 v[12:15], v2 offset:20480
    v_exp_f32 v54, v54
    v_exp_f32 v55, v55
    v_cvt_pk_bf16_f32 v66, v52, v53
    v_exp_f32 v56, v56
    v_exp_f32 v57, v57
    v_cvt_pk_bf16_f32 v67, v54, v55
    v_exp_f32 v58, v58
    v_exp_f32 v59, v59
    v_mfma_f32_32x32x16_bf16 v[72:87], v[24:27], v[64:67], v[72:87]
    v_cvt_pk_bf16_f32 v68, v56, v57
    v_exp_f32 v60, v60
    v_exp_f32 v61, v61
    v_cvt_pk_bf16_f32 v69, v58, v59
    v_exp_f32 v62, v62
    v_exp_f32 v63, v63
    v_cvt_pk_bf16_f32 v70, v60, v61
    v_cvt_pk_bf16_f32 v71, v62, v63
    v_exp_f32 v32, v32
    v_exp_f32 v33, v33
    v_mfma_f32_32x32x16_bf16 v[72:87], v[28:31], v[68:71], v[72:87]
    s_mov_b64 exec, s[20:21]
    ds_read_b128 v[24:27], v3 offset:20480
    ds_read_b128 v[28:31], v3 offset:20992
    s_mov_b64 exec, -1
    v_exp_f32 v34, v34
    v_exp_f32 v35, v35
    v_cvt_pk_bf16_f32 v64, v32, v33
    v_exp_f32 v36, v36
    v_exp_f32 v37, v37
    v_cvt_pk_bf16_f32 v65, v34, v35
    s_waitcnt lgkmcnt(2)
    v_mfma_f32_32x32x16_bf16 v[48:63], v[12:15], v[4:7], 0
    s_sub_u32 s26, s3, 4
    s_cmp_lt_u32 s26, 8
    s_cbranch_scc0 AT_NY0
    v_and_b32 v89, 31, v0
    v_lshrrev_b32 v124, 5, v0
    v_lshlrev_b32 v89, 16, v89
    v_lshl_add_u32 v89, v124, 13, v89
AT_NY0:
    s_mov_b32 s4, s84
    s_mov_b32 s5, s85
    s_mov_b32 s6, 4194304
    s_mov_b32 s7, 0x00020000
    ds_read_b128 v[8:11], v2 offset:24576
    v_exp_f32 v38, v38
    v_exp_f32 v39, v39
    v_cvt_pk_bf16_f32 v66, v36, v37
    v_exp_f32 v40, v40
    v_exp_f32 v41, v41
    v_cvt_pk_bf16_f32 v67, v38, v39
    v_exp_f32 v42, v42
    v_exp_f32 v43, v43
    v_mfma_f32_32x32x16_bf16 v[72:87], v[16:19], v[64:67], v[72:87]
    v_cvt_pk_bf16_f32 v68, v40, v41
    v_exp_f32 v44, v44
    v_exp_f32 v45, v45
    v_cvt_pk_bf16_f32 v69, v42, v43
    v_exp_f32 v46, v46
    v_exp_f32 v47, v47
    v_cvt_pk_bf16_f32 v70, v44, v45
    v_cvt_pk_bf16_f32 v71, v46, v47
    v_exp_f32 v48, v48
    v_exp_f32 v49, v49
    v_mfma_f32_32x32x16_bf16 v[72:87], v[20:23], v[68:71], v[72:87]
    s_mov_b64 exec, s[20:21]
    ds_read_b128 v[16:19], v3 offset:24576
    ds_read_b128 v[20:23], v3 offset:25088
    s_mov_b64 exec, -1
    v_exp_f32 v50, v50
    v_exp_f32 v51, v51
    v_cvt_pk_bf16_f32 v64, v48, v49
    v_exp_f32 v52, v52
    v_exp_f32 v53, v53
    v_cvt_pk_bf16_f32 v65, v50, v51
    s_waitcnt lgkmcnt(2)
    v_mfma_f32_32x32x16_bf16 v[32:47], v[8:11], v[4:7], 0
    s_sub_u32 s26, s3, 4
    s_cmp_lt_u32 s26, 8
    s_cbranch_scc0 AT_NY1
    buffer_store_dword v90, v89, s[4:7], s36 offen
AT_NY1:
    ds_read_b128 v[12:15], v2 offset:28672
    v_exp_f32 v54, v54
    v_exp_f32 v55, v55
    v_cvt_pk_bf16_f32 v66, v52, v53
    v_exp_f32 v56, v56
    v_exp_f32 v57, v57
    v_cvt_pk_bf16_f32 v67, v54, v55
    v_exp_f32 v58, v58
    v_exp_f32 v59, v59
    v_mfma_f32_32x32x16_bf16 v[72:87], v[24:27], v[64:67], v[72:87]
    v_cvt_pk_bf16_f32 v68, v56, v57
    v_exp_f32 v60, v60
    v_exp_f32 v61, v61
    v_cvt_pk_bf16_f32 v69, v58, v59
    v_exp_f32 v62, v62
    v_exp_f32 v63, v63
    v_cvt_pk_bf16_f32 v70, v60, v61
    v_cvt_pk_bf16_f32 v71, v62, v63
    v_exp_f32 v32, v32
    v_exp_f32 v33, v33
    v_mfma_f32_32x32x16_bf16 v[72:87], v[28:31], v[68:71], v[72:87]
    s_mov_b64 exec, s[20:21]
    ds_read_b128 v[24:27], v3 offset:28672
    ds_read_b128 v[28:31], v3 offset:29184
    s_mov_b64 exec, -1
    v_exp_f32 v34, v34
    v_exp_f32 v35, v35
    v_cvt_pk_bf16_f32 v64, v32, v33
    v_exp_f32 v36, v36
    v_exp_f32 v37, v37
    v_cvt_pk_bf16_f32 v65, v34, v35
    s_waitcnt lgkmcnt(2)
    v_mfma_f32_32x32x16_bf16 v[48:63], v[12:15], v[4:7], 0
    s_cmp_eq_u32 s3, 13
    s_cbranch_scc0 AT_N4a
    v_lshlrev_b32 v89, 8, v0
    s_and_b32 s28, s2, 7
    s_lshl_b32 s28, s28, 13
    s_add_u32 s28, s28, 12189696
    s_mov_b32 s30, -1
    s_mov_b32 s31, 0
    s_mov_b64 exec, s[30:31]
    buffer_load_dword v124, v89, s[44:47], s28 offen sc1
    s_mov_b64 exec, -1
AT_N4a:
    s_sub_u32 s26, s3, 4
    s_cmp_lt_u32 s26, 8
    s_cbranch_scc0 AT_NY2
    buffer_store_dword v91, v89, s[4:7], s36 offen offset:2048
AT_NY2:
    ds_read_b128 v[8:11], v2 offset:32768
    v_exp_f32 v38, v38
    v_exp_f32 v39, v39
    v_cvt_pk_bf16_f32 v66, v36, v37
    v_exp_f32 v40, v40
    v_exp_f32 v41, v41
    v_cvt_pk_bf16_f32 v67, v38, v39
    v_exp_f32 v42, v42
    v_exp_f32 v43, v43
    v_mfma_f32_32x32x16_bf16 v[72:87], v[16:19], v[64:67], v[72:87]
    v_cvt_pk_bf16_f32 v68, v40, v41
    v_exp_f32 v44, v44
    v_exp_f32 v45, v45
    v_cvt_pk_bf16_f32 v69, v42, v43
    v_exp_f32 v46, v46
    v_exp_f32 v47, v47
    v_cvt_pk_bf16_f32 v70, v44, v45
    v_cvt_pk_bf16_f32 v71, v46, v47
    v_exp_f32 v48, v48
    v_exp_f32 v49, v49
    v_mfma_f32_32x32x16_bf16 v[72:87], v[20:23], v[68:71], v[72:87]
    s_mov_b64 exec, s[20:21]
    ds_read_b128 v[16:19], v3 offset:32768
    ds_read_b128 v[20:23], v3 offset:33280
    s_mov_b64 exec, -1
    v_exp_f32 v50, v50
    v_exp_f32 v51, v51
    v_cvt_pk_bf16_f32 v64, v48, v49
    v_exp_f32 v52, v52
    v_exp_f32 v53, v53
    v_cvt_pk_bf16_f32 v65, v50, v51
    s_waitcnt lgkmcnt(2)
    v_mfma_f32_32x32x16_bf16 v[32:47], v[8:11], v[4:7], 0
    s_sub_u32 s26, s3, 4
    s_cmp_lt_u32 s26, 8
    s_cbranch_scc0 AT_NY3
    s_add_u32 s36, s36, 4096
    buffer_store_dword v126, v89, s[4:7], s36 offen
AT_NY3:
    ds_read_b128 v[12:15], v2 offset:36864
    v_exp_f32 v54, v54
    v_exp_f32 v55, v55
    v_cvt_pk_bf16_f32 v66, v52, v53
    v_exp_f32 v56, v56
    v_exp_f32 v57, v57
    v_cvt_pk_bf16_f32 v67, v54, v55
    v_exp_f32 v58, v58
    v_exp_f32 v59, v59
    v_mfma_f32_32x32x16_bf16 v[72:87], v[24:27], v[64:67], v[72:87]
    v_cvt_pk_bf16_f32 v68, v56, v57
    v_exp_f32 v60, v60
    v_exp_f32 v61, v61
    v_cvt_pk_bf16_f32 v69, v58, v59
    v_exp_f32 v62, v62
    v_exp_f32 v63, v63
    v_cvt_pk_bf16_f32 v70, v60, v61
    v_cvt_pk_bf16_f32 v71, v62, v63
    s_setprio 0
    v_exp_f32 v32, v32
    v_exp_f32 v33, v33
    v_mfma_f32_32x32x16_bf16 v[72:87], v[28:31], v[68:71], v[72:87]
    s_mov_b64 exec, s[20:21]
    ds_read_b128 v[24:27], v3 offset:36864
    ds_read_b128 v[28:31], v3 offset:37376
    s_mov_b64 exec, -1
    v_exp_f32 v34, v34
    v_exp_f32 v35, v35
    v_cvt_pk_bf16_f32 v64, v32, v33
    v_exp_f32 v36, v36
    v_exp_f32 v37, v37
    v_cvt_pk_bf16_f32 v65, v34, v35
    s_waitcnt lgkmcnt(2)
    v_mfma_f32_32x32x16_bf16 v[48:63], v[12:15], v[4:7], 0
    s_sub_u32 s26, s3, 4
    s_cmp_lt_u32 s26, 8
    s_cbranch_scc0 AT_NY4
    buffer_store_dword v127, v89, s[4:7], s36 offen offset:2048
AT_NY4:
    ds_read_b128 v[8:11], v2 offset:40960
    v_exp_f32 v38, v38
    v_exp_f32 v39, v39
    v_cvt_pk_bf16_f32 v66, v36, v37
    v_exp_f32 v40, v40
    v_exp_f32 v41, v41
    v_cvt_pk_bf16_f32 v67, v38, v39
    v_exp_f32 v42, v42
    v_exp_f32 v43, v43
    v_mfma_f32_32x32x16_bf16 v[72:87], v[16:19], v[64:67], v[72:87]
    v_cvt_pk_bf16_f32 v68, v40, v41
    v_exp_f32 v44, v44
    v_exp_f32 v45, v45
    v_cvt_pk_bf16_f32 v69, v42, v43
    v_exp_f32 v46, v46
    v_exp_f32 v47, v47
    v_cvt_pk_bf16_f32 v70, v44, v45
    v_cvt_pk_bf16_f32 v71, v46, v47
    v_exp_f32 v48, v48
    v_exp_f32 v49, v49
    v_mfma_f32_32x32x16_bf16 v[72:87], v[20:23], v[68:71], v[72:87]
    s_mov_b64 exec, s[20:21]
    ds_read_b128 v[16:19], v3 offset:40960
    ds_read_b128 v[20:23], v3 offset:41472
    s_mov_b64 exec, -1
    v_exp_f32 v50, v50
    v_exp_f32 v51, v51
    v_cvt_pk_bf16_f32 v64, v48, v49
    v_exp_f32 v52, v52
    v_exp_f32 v53, v53
    v_cvt_pk_bf16_f32 v65, v50, v51
    s_waitcnt lgkmcnt(2)
    v_mfma_f32_32x32x16_bf16 v[32:47], v[8:11], v[4:7], 0
    s_cmp_eq_u32 s3, 13
    s_cbranch_scc0 AT_N4b
    s_waitcnt vmcnt(0)
    s_mov_b32 s30, -1
    s_mov_b32 s31, 0
    v_cmp_ne_u32 vcc, s90, v124
    s_nop 1
    s_and_b64 vcc, vcc, s[30:31]
    s_cbranch_vccz AT_P4_ok
    s_mov_b32 s30, -1
    s_mov_b32 s31, 0
    s_mov_b64 exec, s[30:31]
    s_mov_b32 s29, 0
AT_P4:
    buffer_load_dword v124, v89, s[44:47], s28 offen sc1
    s_add_u32 s29, s29, 1
    s_waitcnt vmcnt(0)
    v_cmp_ne_u32 vcc, s90, v124
    s_cmp_gt_u32 s29, 0x10000
    s_cbranch_scc1 AT_P4_x
    s_cbranch_vccz AT_P4_x
    s_sleep 4
    s_branch AT_P4
AT_P4_x:
    s_mov_b64 exec, -1
AT_P4_ok:
    v_mov_b32 v89, 148108
    v_mov_b32 v124, 1
    s_mov_b64 exec, 1
    ds_add_u32 v89, v124
    s_mov_b64 exec, -1
AT_N4b:
    ds_read_b128 v[12:15], v2 offset:45056
    v_exp_f32 v54, v54
    v_exp_f32 v55, v55
    v_cvt_pk_bf16_f32 v66, v52, v53
    v_exp_f32 v56, v56
    v_exp_f32 v57, v57
    v_cvt_pk_bf16_f32 v67, v54, v55
    v_exp_f32 v58, v58
    v_exp_f32 v59, v59
    v_mfma_f32_32x32x16_bf16 v[72:87], v[24:27], v[64:67], v[72:87]
    v_cvt_pk_bf16_f32 v68, v56, v57
    v_exp_f32 v60, v60
    v_exp_f32 v61, v61
    v_cvt_pk_bf16_f32 v69, v58, v59
    v_exp_f32 v62, v62
    v_exp_f32 v63, v63
    v_cvt_pk_bf16_f32 v70, v60, v61
    v_cvt_pk_bf16_f32 v71, v62, v63
    v_exp_f32 v32, v32
    v_exp_f32 v33, v33
    v_mfma_f32_32x32x16_bf16 v[72:87], v[28:31], v[68:71], v[72:87]
    s_mov_b64 exec, s[20:21]
    ds_read_b128 v[24:27], v3 offset:45056
    ds_read_b128 v[28:31], v3 offset:45568
    s_mov_b64 exec, -1
    v_exp_f32 v34, v34
    v_exp_f32 v35, v35
    v_cvt_pk_bf16_f32 v64, v32, v33
    v_exp_f32 v36, v36
    v_exp_f32 v37, v37
    v_cvt_pk_bf16_f32 v65, v34, v35
    s_waitcnt lgkmcnt(2)
    v_mfma_f32_32x32x16_bf16 v[48:63], v[12:15], v[4:7], 0
    s_lshr_b32 s26, s2, 3
    s_lshl_b32 s26, s26, 4
    s_add_u32 s26, s26, s3
    s_cmp_eq_u32 s26, 15
    s_cbranch_scc0 AT_WB26
    buffer_wbl2 sc1
AT_WB26:
    ds_read_b128 v[8:11], v2 offset:49152
    v_exp_f32 v38, v38
    v_exp_f32 v39, v39
    v_cvt_pk_bf16_f32 v66, v36, v37
    v_exp_f32 v40, v40
    v_exp_f32 v41, v41
    v_cvt_pk_bf16_f32 v67, v38, v39
    v_exp_f32 v42, v42
    v_exp_f32 v43, v43
    v_mfma_f32_32x32x16_bf16 v[72:87], v[16:19], v[64:67], v[72:87]
    v_cvt_pk_bf16_f32 v68, v40, v41
    v_exp_f32 v44, v44
    v_exp_f32 v45, v45
    v_cvt_pk_bf16_f32 v69, v42, v43
    v_exp_f32 v46, v46
    v_exp_f32 v47, v47
    v_cvt_pk_bf16_f32 v70, v44, v45
    v_cvt_pk_bf16_f32 v71, v46, v47
    v_exp_f32 v48, v48
    v_exp_f32 v49, v49
    v_mfma_f32_32x32x16_bf16 v[72:87], v[20:23], v[68:71], v[72:87]
    s_mov_b64 exec, s[20:21]
    ds_read_b128 v[16:19], v3 offset:49152
    ds_read_b128 v[20:23], v3 offset:49664
    s_mov_b64 exec, -1
    v_exp_f32 v50, v50
    v_exp_f32 v51, v51
    v_cvt_pk_bf16_f32 v64, v48, v49
    v_exp_f32 v52, v52
    v_exp_f32 v53, v53
    v_cvt_pk_bf16_f32 v65, v50, v51
    s_waitcnt lgkmcnt(2)
    v_mfma_f32_32x32x16_bf16 v[32:47], v[8:11], v[4:7], 0
    ds_read_b128 v[12:15], v2 offset:53248
    v_exp_f32 v54, v54
    v_exp_f32 v55, v55
    v_cvt_pk_bf16_f32 v66, v52, v53
    v_exp_f32 v56, v56
    v_exp_f32 v57, v57
    v_cvt_pk_bf16_f32 v67, v54, v55
    v_exp_f32 v58, v58
    v_exp_f32 v59, v59
    v_mfma_f32_32x32x16_bf16 v[72:87], v[24:27], v[64:67], v[72:87]
    v_cvt_pk_bf16_f32 v68, v56, v57
    v_exp_f32 v60, v60
    v_exp_f32 v61, v61
    v_cvt_pk_bf16_f32 v69, v58, v59
    v_exp_f32 v62, v62
    v_exp_f32 v63, v63
    v_cvt_pk_bf16_f32 v70, v60, v61
    v_cvt_pk_bf16_f32 v71, v62, v63
    v_exp_f32 v32, v32
    v_exp_f32 v33, v33
    v_mfma_f32_32x32x16_bf16 v[72:87], v[28:31], v[68:71], v[72:87]
    s_mov_b64 exec, s[20:21]
    ds_read_b128 v[24:27], v3 offset:53248
    ds_read_b128 v[28:31], v3 offset:53760
    s_mov_b64 exec, -1
    v_exp_f32 v34, v34
    v_exp_f32 v35, v35
    v_cvt_pk_bf16_f32 v64, v32, v33
    v_exp_f32 v36, v36
    v_exp_f32 v37, v37
    v_cvt_pk_bf16_f32 v65, v34, v35
    s_waitcnt lgkmcnt(2)
    v_mfma_f32_32x32x16_bf16 v[48:63], v[12:15], v[4:7], 0
    ds_read_b128 v[8:11], v2 offset:57344
    v_exp_f32 v38, v38
    v_exp_f32 v39, v39
    v_cvt_pk_bf16_f32 v66, v36, v37
    v_exp_f32 v40, v40
    v_exp_f32 v41, v41
    v_cvt_pk_bf16_f32 v67, v38, v39
    v_exp_f32 v42, v42
    v_exp_f32 v43, v43
    v_mfma_f32_32x32x16_bf16 v[72:87], v[16:19], v[64:67], v[72:87]
    v_cvt_pk_bf16_f32 v68, v40, v41
    v_exp_f32 v44, v44
    v_exp_f32 v45, v45
    v_cvt_pk_bf16_f32 v69, v42, v43
    v_exp_f32 v46, v46
    v_exp_f32 v47, v47
    v_cvt_pk_bf16_f32 v70, v44, v45
    v_cvt_pk_bf16_f32 v71, v46, v47
    v_exp_f32 v48, v48
    v_exp_f32 v49, v49
    v_mfma_f32_32x32x16_bf16 v[72:87], v[20:23], v[68:71], v[72:87]
    s_mov_b64 exec, s[20:21]
    ds_read_b128 v[16:19], v3 offset:57344
    ds_read_b128 v[20:23], v3 offset:57856
    s_mov_b64 exec, -1
    v_exp_f32 v50, v50
    v_exp_f32 v51, v51
    v_cvt_pk_bf16_f32 v64, v48, v49
    v_exp_f32 v52, v52
    v_exp_f32 v53, v53
    v_cvt_pk_bf16_f32 v65, v50, v51
    s_waitcnt lgkmcnt(2)
    v_mfma_f32_32x32x16_bf16 v[32:47], v[8:11], v[4:7], 0
    ds_read_b128 v[12:15], v2 offset:61440
    v_exp_f32 v54, v54
    v_exp_f32 v55, v55
    v_cvt_pk_bf16_f32 v66, v52, v53
    v_exp_f32 v56, v56
    v_exp_f32 v57, v57
    v_cvt_pk_bf16_f32 v67, v54, v55
    v_exp_f32 v58, v58
    v_exp_f32 v59, v59
    v_mfma_f32_32x32x16_bf16 v[72:87], v[24:27], v[64:67], v[72:87]
    v_cvt_pk_bf16_f32 v68, v56, v57
    v_exp_f32 v60, v60
    v_exp_f32 v61, v61
    v_cvt_pk_bf16_f32 v69, v58, v59
    v_exp_f32 v62, v62
    v_exp_f32 v63, v63
    v_cvt_pk_bf16_f32 v70, v60, v61
    v_cvt_pk_bf16_f32 v71, v62, v63
    v_exp_f32 v32, v32
    v_exp_f32 v33, v33
    v_mfma_f32_32x32x16_bf16 v[72:87], v[28:31], v[68:71], v[72:87]
    s_mov_b64 exec, s[20:21]
    ds_read_b128 v[24:27], v3 offset:61440
    ds_read_b128 v[28:31], v3 offset:61952
    s_mov_b64 exec, -1
    v_exp_f32 v34, v34
    v_exp_f32 v35, v35
    v_cvt_pk_bf16_f32 v64, v32, v33
    v_exp_f32 v36, v36
    v_exp_f32 v37, v37
    v_cvt_pk_bf16_f32 v65, v34, v35
    s_waitcnt lgkmcnt(2)
    v_mfma_f32_32x32x16_bf16 v[48:63], v[12:15], v[4:7], 0
    v_exp_f32 v38, v38
    v_exp_f32 v39, v39
    v_cvt_pk_bf16_f32 v66, v36, v37
    v_exp_f32 v40, v40
    v_exp_f32 v41, v41
    v_cvt_pk_bf16_f32 v67, v38, v39
    v_exp_f32 v42, v42
    v_exp_f32 v43, v43
    v_mfma_f32_32x32x16_bf16 v[72:87], v[16:19], v[64:67], v[72:87]
    v_cvt_pk_bf16_f32 v68, v40, v41
    v_exp_f32 v44, v44
    v_exp_f32 v45, v45
    v_cvt_pk_bf16_f32 v69, v42, v43
    v_exp_f32 v46, v46
    v_exp_f32 v47, v47
    v_cvt_pk_bf16_f32 v70, v44, v45
    v_cvt_pk_bf16_f32 v71, v46, v47
    v_exp_f32 v48, v48
    v_exp_f32 v49, v49
    v_mfma_f32_32x32x16_bf16 v[72:87], v[20:23], v[68:71], v[72:87]
    v_exp_f32 v50, v50
    v_exp_f32 v51, v51
    v_cvt_pk_bf16_f32 v64, v48, v49
    v_exp_f32 v52, v52
    v_exp_f32 v53, v53
    v_cvt_pk_bf16_f32 v65, v50, v51
    v_exp_f32 v54, v54
    v_exp_f32 v55, v55
    v_cvt_pk_bf16_f32 v66, v52, v53
    v_exp_f32 v56, v56
    v_exp_f32 v57, v57
    v_cvt_pk_bf16_f32 v67, v54, v55
    v_exp_f32 v58, v58
    v_exp_f32 v59, v59
    s_waitcnt lgkmcnt(0)
    v_mfma_f32_32x32x16_bf16 v[72:87], v[24:27], v[64:67], v[72:87]
    v_cvt_pk_bf16_f32 v68, v56, v57
    v_exp_f32 v60, v60
    v_exp_f32 v61, v61
    v_cvt_pk_bf16_f32 v69, v58, v59
    v_exp_f32 v62, v62
    v_exp_f32 v63, v63
    v_cvt_pk_bf16_f32 v70, v60, v61
    v_cvt_pk_bf16_f32 v71, v62, v63
    s_nop 1
    v_mfma_f32_32x32x16_bf16 v[72:87], v[28:31], v[68:71], v[72:87]
    s_nop 15
    v_mov_b32 v89, v80
    s_nop 1
    v_permlane32_swap_b32 v89, v80
    s_nop 1
    v_mov_b32 v80, v89
    s_mov_b32 s28, 0x1f800000
    s_mov_b32 s29, 0x5f800000
    v_cmp_le_f32 vcc, s28, v80
    v_cmp_ge_f32 s[30:31], s29, v80
    s_nop 1
    s_and_b64 vcc, vcc, s[30:31]
    s_cmp_eq_u64 vcc, -1
    s_cbranch_scc0 AT_FALLBACK
AT_COMBINE:
    s_lshl_b32 s17, s15, 11
    s_add_u32 s17, s17, 131072
    v_add_u32 v89, s17, v1
    v_lshlrev_b32 v12, 3, v0
    s_lshl_b32 s17, s15, 9
    s_add_u32 s17, s17, 148480
    v_add_u32 v12, s17, v12
    s_cmp_eq_u32 s16, 0
    s_cbranch_scc1 AT_LOW
    ds_write_b128 v89, v[72:75]
    ds_write_b128 v89, v[76:79] offset:1024
    v_mov_b32 v81, v88
    ds_write_b64 v12, v[80:81]
    s_waitcnt lgkmcnt(0)
    s_barrier
    s_branch AT_DONE
AT_LOW:
    s_barrier
    ds_read_b128 v[32:35], v89
    ds_read_b128 v[36:39], v89 offset:1024
    ds_read_b64 v[40:41], v12
    s_waitcnt lgkmcnt(0)
    v_max_f32 v8, v88, v41
    v_sub_f32 v9, v88, v8
    v_sub_f32 v10, v41, v8
    v_exp_f32 v9, v9
    v_exp_f32 v10, v10
    s_nop 0
    v_mul_f32 v72, v72, v9
    v_mul_f32 v73, v73, v9
    v_mul_f32 v74, v74, v9
    v_mul_f32 v75, v75, v9
    v_mul_f32 v76, v76, v9
    v_mul_f32 v77, v77, v9
    v_mul_f32 v78, v78, v9
    v_mul_f32 v79, v79, v9
    v_mul_f32 v80, v80, v9
    v_fmac_f32 v72, v32, v10
    v_fmac_f32 v73, v33, v10
    v_fmac_f32 v74, v34, v10
    v_fmac_f32 v75, v35, v10
    v_fmac_f32 v76, v36, v10
    v_fmac_f32 v77, v37, v10
    v_fmac_f32 v78, v38, v10
    v_fmac_f32 v79, v39, v10
    v_fmac_f32 v80, v40, v10
    v_rcp_f32 v8, v80
    s_nop 0
    v_mul_f32 v72, v72, v8
    v_mul_f32 v73, v73, v8
    v_mul_f32 v74, v74, v8
    v_mul_f32 v75, v75, v8
    v_mul_f32 v76, v76, v8
    v_mul_f32 v77, v77, v8
    v_mul_f32 v78, v78, v8
    v_mul_f32 v79, v79, v8
    v_cvt_pk_bf16_f32 v64, v72, v73
    v_cvt_pk_bf16_f32 v65, v74, v75
    v_cvt_pk_bf16_f32 v66, v76, v77
    v_cvt_pk_bf16_f32 v67, v78, v79
    s_nop 1
    v_permlane32_swap_b32 v64, v66
    v_permlane32_swap_b32 v65, v67
    s_add_u32 s18, s18, 6291456
    v_cmp_eq_u32 vcc, -1, v64
    v_mov_b32 v12, 0xfffefffe
    s_nop 0
    v_cndmask_b32 v64, v64, v12, vcc
    v_cmp_eq_u32 vcc, -1, v65
    v_mov_b32 v12, 0xfffefffe
    s_nop 0
    v_cndmask_b32 v65, v65, v12, vcc
    v_cmp_eq_u32 vcc, -1, v66
    v_mov_b32 v12, 0xfffefffe
    s_nop 0
    v_cndmask_b32 v66, v66, v12, vcc
    v_cmp_eq_u32 vcc, -1, v67
    v_mov_b32 v12, 0xfffefffe
    s_nop 0
    v_cndmask_b32 v67, v67, v12, vcc
    buffer_store_dwordx4 v[64:67], v1, s[44:47], s18 offen sc1
    v_mov_b32 v12, 148080
    v_mov_b32 v13, 1
    s_mov_b64 exec, 1
    ds_add_u32 v12, v13
    s_mov_b64 exec, -1
AT_DONE:
    s_and_b32 s12, s2, 7
    s_lshl_b32 s12, s12, 3
    s_lshr_b32 s13, s2, 5
    s_add_u32 s12, s12, s13
    s_lshr_b32 s13, s2, 3
    s_and_b32 s13, s13, 3
    v_and_b32 v4, 15, v0
    v_lshrrev_b32 v5, 4, v0
    v_lshlrev_b32 v14, 9, v5
    v_lshl_add_u32 v14, v4, 4, v14
    s_lshl_b32 s17, s16, 14
    s_add_u32 s17, s17, 0
    v_add_u32 v14, s17, v14
    v_lshlrev_b32 v15, 11, v4
    v_lshl_add_u32 v15, v5, 3, v15
    s_lshl_b32 s20, s12, 16
    s_lshl_b32 s19, s16, 15
    s_add_u32 s20, s20, s19
    s_lshl_b32 s19, s13, 8
    s_add_u32 s20, s20, s19
    s_lshl_b32 s19, s15, 5
    s_add_u32 s20, s20, s19
    s_add_u32 s20, s20, 1024
    s_mov_b32 s4, s84
    s_mov_b32 s5, s85
    s_mov_b32 s6, 4194304
    s_mov_b32 s7, 0x00020000
    s_lshl_b32 s17, s3, 10
    s_add_u32 s17, s17, 32768
    v_add_u32 v6, s17, v1
    s_xor_b32 s17, s17, 8192
    v_add_u32 v7, s17, v1
    s_lshl_b32 s17, s3, 17
    s_lshl_b32 s18, s12, 10
    s_add_u32 s17, s17, s18
    s_add_u32 s17, s17, 6291456
    s_lshl_b32 s18, s3, 11
    s_add_u32 s18, s18, 0
    v_add_u32 v13, s18, v1
    v_mov_b32 v8, 148108
    s_mov_b32 s43, 0
LW_18:
    ds_read_b32 v9, v8
    s_add_u32 s43, s43, 1
    s_waitcnt lgkmcnt(0)
    v_readfirstlane_b32 s42, v9
    s_cmp_gt_u32 s43, 0x80000
    s_cbranch_scc1 LW_18_x
    s_cmp_ge_u32 s42, 1
    s_cbranch_scc1 LW_18_x
    s_sleep 1
    s_branch LW_18
LW_18_x:
    v_mov_b32 v8, 148080
    s_mov_b32 s43, 0
LW_19:
    ds_read_b32 v9, v8
    s_add_u32 s43, s43, 1
    s_waitcnt lgkmcnt(0)
    v_readfirstlane_b32 s42, v9
    s_cmp_gt_u32 s43, 0x80000
    s_cbranch_scc1 LW_19_x
    s_cmp_ge_u32 s42, 8
    s_cbranch_scc1 LW_19_x
    s_sleep 1
    s_branch LW_19
LW_19_x:
    s_add_u32 s18, s17, 65536
    s_mov_b32 s29, 0
    s_mov_b32 s28, 3
TL_POLL:
    s_bitcmp1_b32 s28, 0
    s_cbranch_scc0 TL_P1
    buffer_load_dwordx4 v[16:19], v1, s[44:47], s17 offen sc1
TL_P1:
    s_bitcmp1_b32 s28, 1
    s_cbranch_scc0 TL_P2
    buffer_load_dwordx4 v[20:23], v1, s[44:47], s18 offen sc1
TL_P2:
    s_add_u32 s29, s29, 1
    s_waitcnt vmcnt(0)
    v_max3_u32 v8, v16, v17, v18
    v_max3_u32 v9, v20, v21, v22
    v_max_u32 v8, v8, v19
    v_max_u32 v9, v9, v23
    v_cmp_eq_u32 vcc, -1, v8
    v_cmp_eq_u32 s[30:31], -1, v9
    s_nop 1
    s_cmp_lg_u64 vcc, 0
    s_cselect_b32 s28, 1, 0
    s_cmp_lg_u64 s[30:31], 0
    s_cselect_b32 s19, 2, 0
    s_or_b32 s28, s28, s19
    s_cmp_gt_u32 s29, 0x8000
    s_cbranch_scc1 TL_GOT
    s_cmp_eq_u32 s28, 0
    s_cbranch_scc1 TL_GOT
    s_sleep 2
    s_branch TL_POLL
TL_GOT:
    ds_write_b128 v13, v[16:19]
    ds_write_b128 v13, v[20:23] offset:1024
    s_waitcnt lgkmcnt(0)
    s_barrier
    ds_read_b128 v[16:19], v14 offset:0
    ds_read_b128 v[28:31], v14 offset:256
    ds_read_b128 v[20:23], v14 offset:2048
    ds_read_b128 v[32:35], v14 offset:2304
    ds_read_b128 v[24:27], v14 offset:4096
    ds_read_b128 v[36:39], v14 offset:4352
    s_waitcnt lgkmcnt(5)
    v_mfma_f32_16x16x32_bf16 v[40:43], v[92:95], v[16:19], 0
    s_waitcnt lgkmcnt(4)
    v_mfma_f32_16x16x32_bf16 v[44:47], v[92:95], v[28:31], 0
    ds_read_b128 v[16:19], v14 offset:6144
    ds_read_b128 v[28:31], v14 offset:6400
    s_waitcnt lgkmcnt(5)
    v_mfma_f32_16x16x32_bf16 v[40:43], v[96:99], v[20:23], v[40:43]
    s_waitcnt lgkmcnt(4)
    v_mfma_f32_16x16x32_bf16 v[44:47], v[96:99], v[32:35], v[44:47]
    ds_read_b128 v[20:23], v14 offset:8192
    ds_read_b128 v[32:35], v14 offset:8448
    s_waitcnt lgkmcnt(5)
    v_mfma_f32_16x16x32_bf16 v[40:43], v[100:103], v[24:27], v[40:43]
    s_waitcnt lgkmcnt(4)
    v_mfma_f32_16x16x32_bf16 v[44:47], v[100:103], v[36:39], v[44:47]
    ds_read_b128 v[24:27], v14 offset:10240
    ds_read_b128 v[36:39], v14 offset:10496
    s_waitcnt lgkmcnt(5)
    v_mfma_f32_16x16x32_bf16 v[40:43], v[104:107], v[16:19], v[40:43]
    s_waitcnt lgkmcnt(4)
    v_mfma_f32_16x16x32_bf16 v[44:47], v[104:107], v[28:31], v[44:47]
    ds_read_b128 v[16:19], v14 offset:12288
    ds_read_b128 v[28:31], v14 offset:12544
    s_waitcnt lgkmcnt(5)
    v_mfma_f32_16x16x32_bf16 v[40:43], v[108:111], v[20:23], v[40:43]
    s_waitcnt lgkmcnt(4)
    v_mfma_f32_16x16x32_bf16 v[44:47], v[108:111], v[32:35], v[44:47]
    ds_read_b128 v[20:23], v14 offset:14336
    ds_read_b128 v[32:35], v14 offset:14592
    s_waitcnt lgkmcnt(5)
    v_mfma_f32_16x16x32_bf16 v[40:43], v[112:115], v[24:27], v[40:43]
    s_waitcnt lgkmcnt(4)
    v_mfma_f32_16x16x32_bf16 v[44:47], v[112:115], v[36:39], v[44:47]
    s_waitcnt lgkmcnt(3)
    v_mfma_f32_16x16x32_bf16 v[40:43], v[116:119], v[16:19], v[40:43]
    s_waitcnt lgkmcnt(2)
    v_mfma_f32_16x16x32_bf16 v[44:47], v[116:119], v[28:31], v[44:47]
    s_waitcnt lgkmcnt(1)
    v_mfma_f32_16x16x32_bf16 v[40:43], v[120:123], v[20:23], v[40:43]
    s_waitcnt lgkmcnt(0)
    v_mfma_f32_16x16x32_bf16 v[44:47], v[120:123], v[32:35], v[44:47]
    s_cmp_eq_u32 s2, 0
    s_cbranch_scc0 TL_NE
    s_cmp_eq_u32 s3, 8
    s_cbranch_scc0 TL_NE
    s_mov_b32 s17, 12124160
    v_mov_b32 v12, s90
    v_mov_b32 v13, 0
    s_mov_b64 exec, 1
    buffer_store_dword v12, v13, s[44:47], s17 offen sc1
    s_mov_b64 exec, -1
TL_NE:
    s_nop 7
    s_cmp_eq_u32 s16, 0
    s_cbranch_scc1 TL_LO
    ds_write_b128 v6, v[40:43]
    v_mov_b32 v40, v44
    v_mov_b32 v41, v45
    v_mov_b32 v42, v46
    v_mov_b32 v43, v47
    s_branch TL_X
TL_LO:
    ds_write_b128 v6, v[44:47]
TL_X:
    s_waitcnt lgkmcnt(0)
    s_barrier
    ds_read_b128 v[16:19], v7
    s_waitcnt lgkmcnt(0)
    v_add_f32 v40, v40, v16
    v_add_f32 v41, v41, v17
    v_add_f32 v42, v42, v18
    v_add_f32 v43, v43, v19
    v_cvt_pk_bf16_f32 v48, v40, v41
    v_cvt_pk_bf16_f32 v49, v42, v43
    buffer_store_dwordx2 v[48:49], v15, s[4:7], s20 offen
K_FIN:
    s_waitcnt vmcnt(0)
K_END:
    s_endpgm
AT_FALLBACK:
    v_mov_b32 v88, 0xff800000
    v_subrev_u32 v89, 65536, v2
    s_mov_b32 s17, 0
AT_FB1:
    ds_read_b128 v[8:11], v89
    v_add_u32 v89, 4096, v89
    s_waitcnt lgkmcnt(0)
    v_mfma_f32_32x32x16_bf16 v[32:47], v[8:11], v[4:7], 0
    s_nop 15
    v_max3_f32 v88, v32, v33, v88
    v_max3_f32 v88, v34, v35, v88
    v_max3_f32 v88, v36, v37, v88
    v_max3_f32 v88, v38, v39, v88
    v_max3_f32 v88, v40, v41, v88
    v_max3_f32 v88, v42, v43, v88
    v_max3_f32 v88, v44, v45, v88
    v_max3_f32 v88, v46, v47, v88
    s_add_u32 s17, s17, 1
    s_cmp_lt_u32 s17, 32
    s_cbranch_scc1 AT_FB1
    v_mov_b32 v89, v88
    v_mov_b32 v12, v88
    s_nop 1
    v_permlane32_swap_b32 v89, v12
    s_nop 1
    v_max_f32 v88, v89, v12
    v_mov_b32 v72, 0
    v_mov_b32 v73, 0
    v_mov_b32 v74, 0
    v_mov_b32 v75, 0
    v_mov_b32 v76, 0
    v_mov_b32 v77, 0
    v_mov_b32 v78, 0
    v_mov_b32 v79, 0
    v_mov_b32 v80, 0
    v_mov_b32 v81, 0
    v_mov_b32 v82, 0
    v_mov_b32 v83, 0
    v_mov_b32 v84, 0
    v_mov_b32 v85, 0
    v_mov_b32 v86, 0
    v_mov_b32 v87, 0
    v_subrev_u32 v89, 65536, v2
    v_subrev_u32 v12, 65536, v3
    s_mov_b32 s17, 0
AT_FB2:
    ds_read_b128 v[8:11], v89
    s_mov_b64 exec, s[20:21]
    ds_read_b128 v[16:19], v12
    ds_read_b128 v[20:23], v12 offset:512
    s_mov_b64 exec, -1
    v_add_u32 v89, 4096, v89
    v_add_u32 v12, 4096, v12
    s_waitcnt lgkmcnt(0)
    v_mfma_f32_32x32x16_bf16 v[32:47], v[8:11], v[4:7], 0
    s_nop 15
    v_sub_f32 v32, v32, v88
    v_sub_f32 v33, v33, v88
    v_sub_f32 v34, v34, v88
    v_sub_f32 v35, v35, v88
    v_sub_f32 v36, v36, v88
    v_sub_f32 v37, v37, v88
    v_sub_f32 v38, v38, v88
    v_sub_f32 v39, v39, v88
    v_sub_f32 v40, v40, v88
    v_sub_f32 v41, v41, v88
    v_sub_f32 v42, v42, v88
    v_sub_f32 v43, v43, v88
    v_sub_f32 v44, v44, v88
    v_sub_f32 v45, v45, v88
    v_sub_f32 v46, v46, v88
    v_sub_f32 v47, v47, v88
    v_exp_f32 v32, v32
    v_exp_f32 v33, v33
    v_exp_f32 v34, v34
    v_exp_f32 v35, v35
    v_exp_f32 v36, v36
    v_exp_f32 v37, v37
    v_exp_f32 v38, v38
    v_exp_f32 v39, v39
    v_exp_f32 v40, v40
    v_exp_f32 v41, v41
    v_exp_f32 v42, v42
    v_exp_f32 v43, v43
    v_exp_f32 v44, v44
    v_exp_f32 v45, v45
    v_exp_f32 v46, v46
    v_exp_f32 v47, v47
    s_nop 0
    v_cvt_pk_bf16_f32 v64, v32, v33
    v_cvt_pk_bf16_f32 v65, v34, v35
    v_cvt_pk_bf16_f32 v66, v36, v37
    v_cvt_pk_bf16_f32 v67, v38, v39
    v_cvt_pk_bf16_f32 v68, v40, v41
    v_cvt_pk_bf16_f32 v69, v42, v43
    v_cvt_pk_bf16_f32 v70, v44, v45
    v_cvt_pk_bf16_f32 v71, v46, v47
    s_nop 1
    v_mfma_f32_32x32x16_bf16 v[72:87], v[16:19], v[64:67], v[72:87]
    v_mfma_f32_32x32x16_bf16 v[72:87], v[20:23], v[68:71], v[72:87]
    s_add_u32 s17, s17, 1
    s_cmp_lt_u32 s17, 32
    s_cbranch_scc1 AT_FB2
    s_nop 15
    v_mov_b32 v89, v80
    s_nop 1
    v_permlane32_swap_b32 v89, v80
    s_nop 1
    v_mov_b32 v80, v89
    s_branch AT_COMBINE
    .p2align 6
    .type GTAB,@object
GTAB:
    .long 1280, 1280, 1280, 1280, 1278, 1278, 1278, 1278, 1278, 1278, 1278, 1276, 1276, 1276, 1276, 1276
    .long 1276, 1276, 1276, 1276, 1274, 1274, 1274, 1274, 1274, 1274, 1274, 1272, 1272, 1272, 1272, 1272
    .long 1272, 1272, 1272, 1272, 1270, 1270, 1270, 1270, 1270, 1270, 1270, 1268, 1268, 1268, 1268, 1268
    .long 1268, 1268, 1268, 1268, 1266, 1266, 1266, 1266, 1266, 1266, 1266, 1264, 1264, 1264, 1264, 1264
    .long 1264, 1264, 1264, 1264, 1262, 1262, 1262, 1262, 1262, 1262, 1262, 1260, 1260, 1260, 1260, 1260
    .long 1260, 1260, 1260, 1260, 1258, 1258, 1258, 1258, 1258, 1258, 1258, 1256, 1256, 1256, 1256, 1256
    .long 1256, 1256, 1256, 1256, 1254, 1254, 1254, 1254, 1254, 1254, 1254, 1252, 1252, 1252, 1252, 1252
    .long 1252, 1252, 1252, 1252, 1250, 1250, 1250, 1250, 1250, 1250, 1250, 1248, 1248, 1248, 1248, 1248
    .long 1248, 1248, 1248, 1248, 1246, 1246, 1246, 1246, 1246, 1246, 1246, 1244, 1244, 1244, 1244, 1244
    .long 1244, 1244, 1244, 1244, 1242, 1242, 1242, 1242, 1242, 1242, 1242, 1240, 1240, 1240, 1240, 1240
    .long 1240, 1240, 1240, 1240, 1238, 1238, 1238, 1238, 1238, 1238, 1238, 1236, 1236, 1236, 1236, 1236
    .long 1236, 1236, 1236, 1236, 1234, 1234, 1234, 1234, 1234, 1234, 1234, 1232, 1232, 1232, 1232, 1232
    .long 1232, 1232, 1232, 1232, 1230, 1230, 1230, 1230, 1230, 1230, 1230, 1228, 1228, 1228, 1228, 1228
    .long 1228, 1228, 1228, 1228, 1226, 1226, 1226, 1226, 1226, 1226, 1226, 1224, 1224, 1224, 1224, 1224
    .long 1224, 1224, 1224, 1224, 1222, 1222, 1222, 1222, 1222, 1222, 1222, 1220, 1220, 1220, 1220, 1220
    .long 1220, 1220, 1220, 1220, 1218, 1218, 1218, 1218, 1218, 1218, 1218, 1216, 1216, 1216, 1216, 1216
    .long 1216, 1216, 1216, 1216, 1214, 1214, 1214, 1214, 1214, 1214, 1214, 1212, 1212, 1212, 1212, 1212
    .long 1212, 1212, 1212, 1212, 1210, 1210, 1210, 1210, 1210, 1210, 1210, 1208, 1208, 1208, 1208, 1208
    .long 1208, 1208, 1208, 1208, 1206, 1206, 1206, 1206, 1206, 1206, 1206, 1204, 1204, 1204, 1204, 1204
    .long 1204, 1204, 1204, 1204, 1202, 1202, 1202, 1202, 1202, 1202, 1202, 1200, 1200, 1200, 1200, 1200
    .long 1200, 1200, 1200, 1200, 1198, 1198, 1198, 1198, 1198, 1198, 1198, 1196, 1196, 1196, 1196, 1196
    .long 1196, 1196, 1196, 1196, 1194, 1194, 1194, 1194, 1194, 1194, 1194, 1192, 1192, 1192, 1192, 1192
    .long 1192, 1192, 1192, 1192, 1190, 1190, 1190, 1190, 1190, 1190, 1190, 1188, 1188, 1188, 1188, 1188
    .long 1188, 1188, 1188, 1188, 1186, 1186, 1186, 1186, 1186, 1186, 1186, 1184, 1184, 1184, 1184, 1184
    .long 1184, 1184, 1184, 1184, 1182, 1182, 1182, 1182, 1182, 1182, 1182, 1180, 1180, 1180, 1180, 1180
    .long 1180, 1180, 1180, 1180, 1178, 1178, 1178, 1178, 1178, 1178, 1178, 1176, 1176, 1176, 1176, 1176
    .long 1176, 1176, 1176, 1176, 1174, 1174, 1174, 1174, 1174, 1174, 1174, 1172, 1172, 1172, 1172, 1172
    .long 1172, 1172, 1172, 1172, 1170, 1170, 1170, 1170, 1170, 1170, 1170, 1168, 1168, 1168, 1168, 1168
    .long 1168, 1168, 1168, 1168, 1166, 1166, 1166, 1166, 1166, 1166, 1166, 1164, 1164, 1164, 1164, 1164
    .long 1164, 1164, 1164, 1164, 1162, 1162, 1162, 1162, 1162, 1162, 1162, 1160, 1160, 1160, 1160, 1160
    .long 1160, 1160, 1160, 1160, 1158, 1158, 1158, 1158, 1158, 1158, 1158, 1156, 1156, 1156, 1156, 1156
    .long 1156, 1156, 1156, 1156, 1154, 1154, 1154, 1154, 1154, 1154, 1154, 1152, 1152, 1152, 1152, 1152
    .long 1152, 1152, 1152, 1152, 1150, 1150, 1150, 1150, 1150, 1150, 1150, 1148, 1148, 1148, 1148, 1148
    .long 1148, 1148, 1148, 1148, 1146, 1146, 1146, 1146, 1146, 1146, 1146, 1144, 1144, 1144, 1144, 1144
    .long 1144, 1144, 1144, 1144, 1142, 1142, 1142, 1142, 1142, 1142, 1142, 1140, 1140, 1140, 1140, 1140
    .long 1140, 1140, 1140, 1140, 1138, 1138, 1138, 1138, 1138, 1138, 1138, 1136, 1136, 1136, 1136, 1136
    .long 1136, 1136, 1136, 1136, 1134, 1134, 1134, 1134, 1134, 1134, 1134, 1132, 1132, 1132, 1132, 1132
    .long 1132, 1132, 1132, 1132, 1130, 1130, 1130, 1130, 1130, 1130, 1130, 1128, 1128, 1128, 1128, 1128
    .long 1128, 1128, 1128, 1128, 1126, 1126, 1126, 1126, 1126, 1126, 1126, 1124, 1124, 1124, 1124, 1124
    .long 1124, 1124, 1124, 1124, 1122, 1122, 1122, 1122, 1122, 1122, 1122, 1120, 1120, 1120, 1120, 1120
    .long 1120, 1120, 1120, 1120, 1118, 1118, 1118, 1118, 1118, 1118, 1118, 1116, 1116, 1116, 1116, 1116
    .long 1116, 1116, 1116, 1116, 1114, 1114, 1114, 1114, 1114, 1114, 1114, 1112, 1112, 1112, 1112, 1112
    .long 1112, 1112, 1112, 1112, 1110, 1110, 1110, 1110, 1110, 1110, 1110, 1108, 1108, 1108, 1108, 1108
    .long 1108, 1108, 1108, 1108, 1106, 1106, 1106, 1106, 1106, 1106, 1106, 1104, 1104, 1104, 1104, 1104
    .long 1104, 1104, 1104, 1104, 1102, 1102, 1102, 1102, 1102, 1102, 1102, 1100, 1100, 1100, 1100, 1100
    .long 1100, 1100, 1100, 1100, 1098, 1098, 1098, 1098, 1098, 1098, 1098, 1096, 1096, 1096, 1096, 1096
    .long 1096, 1096, 1096, 1096, 1094, 1094, 1094, 1094, 1094, 1094, 1094, 1092, 1092, 1092, 1092, 1092
    .long 1092, 1092, 1092, 1092, 1090, 1090, 1090, 1090, 1090, 1090, 1090, 1088, 1088, 1088, 1088, 1088
    .long 1088, 1088, 1088, 1088, 1086, 1086, 1086, 1086, 1086, 1086, 1086, 1084, 1084, 1084, 1084, 1084
    .long 1084, 1084, 1084, 1084, 1082, 1082, 1082, 1082, 1082, 1082, 1082, 1080, 1080, 1080, 1080, 1080
    .long 1080, 1080, 1080, 1080, 1078, 1078, 1078, 1078, 1078, 1078, 1078, 1076, 1076, 1076, 1076, 1076
    .long 1076, 1076, 1076, 1076, 1074, 1074, 1074, 1074, 1074, 1074, 1074, 1072, 1072, 1072, 1072, 1072
    .long 1072, 1072, 1072, 1072, 1070, 1070, 1070, 1070, 1070, 1070, 1070, 1068, 1068, 1068, 1068, 1068
    .long 1068, 1068, 1068, 1068, 1066, 1066, 1066, 1066, 1066, 1066, 1066, 1064, 1064, 1064, 1064, 1064
    .long 1064, 1064, 1064, 1064, 1062, 1062, 1062, 1062, 1062, 1062, 1062, 1060, 1060, 1060, 1060, 1060
    .long 1060, 1060, 1060, 1060, 1058, 1058, 1058, 1058, 1058, 1058, 1058, 1056, 1056, 1056, 1056, 1056
    .long 1056, 1056, 1056, 1056, 1054, 1054, 1054, 1054, 1054, 1054, 1054, 1052, 1052, 1052, 1052, 1052
    .long 1052, 1052, 1052, 1052, 1050, 1050, 1050, 1050, 1050, 1050, 1050, 1048, 1048, 1048, 1048, 1048
    .long 1048, 1048, 1048, 1048, 1046, 1046, 1046, 1046, 1046, 1046, 1046, 1044, 1044, 1044, 1044, 1044
    .long 1044, 1044, 1044, 1044, 1042, 1042, 1042, 1042, 1042, 1042, 1042, 1040, 1040, 1040, 1040, 1040
    .long 1040, 1040, 1040, 1040, 1038, 1038, 1038, 1038, 1038, 1038, 1038, 1036, 1036, 1036, 1036, 1036
    .long 1036, 1036, 1036, 1036, 1034, 1034, 1034, 1034, 1034, 1034, 1034, 1032, 1032, 1032, 1032, 1032
    .long 1032, 1032, 1032, 1032, 1030, 1030, 1030, 1030, 1030, 1030, 1030, 1028, 1028, 1028, 1028, 1028
    .long 1028, 1028, 1028, 1028, 1026, 1026, 1026, 1026, 1026, 1026, 1026, 1024, 1024, 1024, 1024, 1024
    .long 1024, 1024, 1022, 1022, 1022, 958, 958, 958, 958, 958, 1020, 1020, 1020, 956, 956, 956
    .long 956, 956, 1018, 1018, 1018, 954, 954, 954, 954, 954, 1016, 1016, 1016, 952, 952, 952
    .long 952, 952, 1014, 1014, 1014, 950, 950, 950, 950, 950, 1012, 1012, 1012, 948, 948, 948
    .long 948, 948, 1010, 1010, 1010, 946, 946, 946, 946, 946, 1008, 1008, 1008, 944, 944, 944
    .long 944, 944, 1006, 1006, 1006, 942, 942, 942, 942, 942, 1004, 1004, 1004, 940, 940, 940
    .long 940, 940, 1002, 1002, 1002, 938, 938, 938, 938, 938, 1000, 1000, 1000, 936, 936, 936
    .long 936, 936, 998, 998, 998, 934, 934, 934, 934, 934, 996, 996, 996, 932, 932, 932
    .long 932, 932, 994, 994, 994, 930, 930, 930, 930, 930, 992, 992, 992, 928, 928, 928
    .long 928, 928, 990, 990, 990, 926, 926, 926, 926, 926, 988, 988, 988, 924, 924, 924
    .long 924, 924, 986, 986, 986, 922, 922, 922, 922, 922, 984, 984, 984, 920, 920, 920
    .long 920, 920, 982, 982, 982, 918, 918, 918, 918, 918, 980, 980, 980, 916, 916, 916
    .long 916, 916, 978, 978, 978, 914, 914, 914, 914, 914, 976, 976, 976, 912, 912, 912
    .long 912, 912, 974, 974, 974, 910, 910, 910, 910, 910, 972, 972, 972, 908, 908, 908
    .long 908, 908, 970, 970, 970, 906, 906, 906, 906, 906, 968, 968, 968, 904, 904, 904
    .long 904, 904, 966, 966, 966, 902, 902, 902, 902, 902, 964, 964, 964, 900, 900, 900
    .long 900, 900, 962, 962, 962, 898, 898, 898, 898, 898, 960, 960, 960, 896, 896, 896
    .long 896, 896, 894, 894, 894, 830, 830, 830, 830, 830, 892, 892, 892, 828, 828, 828
    .long 828, 828, 890, 890, 890, 826, 826, 826, 826, 826, 888, 888, 888, 824, 824, 824
    .long 824, 824, 886, 886, 886, 822, 822, 822, 822, 822, 884, 884, 884, 820, 820, 820
    .long 820, 820, 882, 882, 882, 818, 818, 818, 818, 818, 880, 880, 880, 816, 816, 816
    .long 816, 816, 878, 878, 878, 814, 814, 814, 814, 814, 876, 876, 876, 812, 812, 812
    .long 812, 812, 874, 874, 874, 810, 810, 810, 810, 810, 872, 872, 872, 808, 808, 808
    .long 808, 808, 870, 870, 870, 806, 806, 806, 806, 806, 868, 868, 868, 804, 804, 804
    .long 804, 804, 866, 866, 866, 802, 802, 802, 802, 802, 864, 864, 864, 800, 800, 800
    .long 800, 800, 862, 862, 862, 798, 798, 798, 798, 798, 860, 860, 860, 796, 796, 796
    .long 796, 796, 858, 858, 858, 794, 794, 794, 794, 794, 856, 856, 856, 792, 792, 792
    .long 792, 792, 854, 854, 854, 790, 790, 790, 790, 790, 852, 852, 852, 788, 788, 788
    .long 788, 788, 850, 850, 850, 786, 786, 786, 786, 786, 848, 848, 848, 784, 784, 784
    .long 784, 784, 846, 846, 846, 782, 782, 782, 782, 782, 844, 844, 844, 780, 780, 780
    .long 780, 780, 842, 842, 842, 778, 778, 778, 778, 778, 840, 840, 840, 776, 776, 776
    .long 776, 776, 838, 838, 838, 774, 774, 774, 774, 774, 836, 836, 836, 772, 772, 772
    .long 772, 772, 834, 834, 834, 770, 770, 770, 770, 770, 832, 832, 832, 768, 768, 768
    .long 768, 766, 702, 702, 702, 638, 574, 574, 574, 764, 700, 700, 700, 636, 572, 572
    .long 572, 762, 698, 698, 698, 634, 570, 570, 570, 760, 696, 696, 696, 632, 568, 568
    .long 568, 758, 694, 694, 694, 630, 566, 566, 566, 756, 692, 692, 692, 628, 564, 564
    .long 564, 754, 690, 690, 690, 626, 562, 562, 562, 752, 688, 688, 688, 624, 560, 560
    .long 560, 750, 686, 686, 686, 622, 558, 558, 558, 748, 684, 684, 684, 620, 556, 556
    .long 556, 746, 682, 682, 682, 618, 554, 554, 554, 744, 680, 680, 680, 616, 552, 552
    .long 552, 742, 678, 678, 678, 614, 550, 550, 550, 740, 676, 676, 676, 612, 548, 548
    .long 548, 738, 674, 674, 674, 610, 546, 546, 546, 736, 672, 672, 672, 608, 544, 544
    .long 544, 734, 670, 670, 670, 606, 542, 542, 542, 732, 668, 668, 668, 604, 540, 540
    .long 540, 730, 666, 666, 666, 602, 538, 538, 538, 728, 664, 664, 664, 600, 536, 536
    .long 536, 726, 662, 662, 662, 598, 534, 534, 534, 724, 660, 660, 660, 596, 532, 532
    .long 532, 722, 658, 658, 658, 594, 530, 530, 530, 720, 656, 656, 656, 592, 528, 528
    .long 528, 718, 654, 654, 654, 590, 526, 526, 526, 716, 652, 652, 652, 588, 524, 524
    .long 524, 714, 650, 650, 650, 586, 522, 522, 522, 712, 648, 648, 648, 584, 520, 520
    .long 520, 710, 646, 646, 646, 582, 518, 518, 518, 708, 644, 644, 644, 580, 516, 516
    .long 516, 706, 642, 642, 642, 578, 514, 514, 514, 704, 640, 640, 640, 576, 512, 512
    .long 510, 446, 382, 318, 254, 190, 126, 62, 508, 444, 380, 316, 252, 188, 124, 60
    .long 506, 442, 378, 314, 250, 186, 122, 58, 504, 440, 376, 312, 248, 184, 120, 56
    .long 502, 438, 374, 310, 246, 182, 118, 54, 500, 436, 372, 308, 244, 180, 116, 52
    .long 498, 434, 370, 306, 242, 178, 114, 50, 496, 432, 368, 304, 240, 176, 112, 48
    .long 494, 430, 366, 302, 238, 174, 110, 46, 492, 428, 364, 300, 236, 172, 108, 44
    .long 490, 426, 362, 298, 234, 170, 106, 42, 488, 424, 360, 296, 232, 168, 104, 40
    .long 486, 422, 358, 294, 230, 166, 102, 38, 484, 420, 356, 292, 228, 164, 100, 36
    .long 482, 418, 354, 290, 226, 162, 98, 34, 480, 416, 352, 288, 224, 160, 96, 32
    .long 478, 414, 350, 286, 222, 158, 94, 30, 476, 412, 348, 284, 220, 156, 92, 28
    .long 474, 410, 346, 282, 218, 154, 90, 26, 472, 408, 344, 280, 216, 152, 88, 24
    .long 470, 406, 342, 278, 214, 150, 86, 22, 468, 404, 340, 276, 212, 148, 84, 20
    .long 466, 402, 338, 274, 210, 146, 82, 18, 464, 400, 336, 272, 208, 144, 80, 16
    .long 462, 398, 334, 270, 206, 142, 78, 14, 460, 396, 332, 268, 204, 140, 76, 12
    .long 458, 394, 330, 266, 202, 138, 74, 10, 456, 392, 328, 264, 200, 136, 72, 8
    .long 454, 390, 326, 262, 198, 134, 70, 6, 452, 388, 324, 260, 196, 132, 68, 4
    .long 450, 386, 322, 258, 194, 130, 66, 2, 448, 384, 320, 256, 192, 128, 64, 0
    .size GTAB, 8192
GTAB_END:
.section .rodata,"a"
.p2align 6
.amdhsa_kernel concat_heads__ssm_conv_s4d__mha_block__prompt_kernel
  .amdhsa_next_free_vgpr 128
  .amdhsa_next_free_sgpr 100
  .amdhsa_accum_offset 128
  .amdhsa_group_segment_fixed_size 0
  .amdhsa_kernarg_size 104
  .amdhsa_user_sgpr_count 2
  .amdhsa_user_sgpr_kernarg_segment_ptr 1
  .amdhsa_system_sgpr_workgroup_id_x 1
.end_amdhsa_kernel
```
